```python
import torch

def _softmax(x, axis=-1):
    return torch.softmax(x, dim=axis)
def _gelu(x):
    return torch.nn.functional.gelu(x, approximate="tanh")
def _silu(x):
    return torch.nn.functional.silu(x)
def _sigmoid(x):
    return torch.sigmoid(x)
def _layernorm(x, axis=-1, eps=1e-5):
    m = x.mean(dim=axis, keepdim=True)
    v = x.var(dim=axis, keepdim=True, unbiased=False)
    return (x - m) / torch.sqrt(v + eps)
def _scatter_add(tgt, idx, src, axis=0):
    return tgt.clone().index_add_(axis, idx, src)
def _segment_sum(src, seg, n):
    out = torch.zeros((n,) + src.shape[1:], dtype=src.dtype)
    return out.index_add_(0, seg, src)
def _pad(x, pw):
    flat = tuple(v for pair in reversed(pw) for v in pair)
    return torch.nn.functional.pad(x, flat)

kernel_name = 'interleave_layers__linear_kernel_hedgehog__sliding_local_dilated__prompt'

def setup_inputs():

    _w = (lambda a: (lambda t: t.to(torch.bfloat16) if t.is_floating_point() else t)(torch.as_tensor(a)))
    def _A_setup():
        B, S, D, H = 1, 2048, 512, 32
        Dh = D // H
        return {
            "x": _w((lambda *s: torch.randn(*s, dtype=torch.bfloat16) * 0.05)(B, S, D)),
            "wqkv": _w((lambda *s: torch.randn(*s, dtype=torch.bfloat16) * 0.4)(D, 3 * D)),
            "w_phi": _w((lambda *s: torch.randn(*s, dtype=torch.bfloat16) * 0.4)(H, Dh, Dh) * (Dh ** -0.5)),
            "wo": _w((lambda *s: torch.randn(*s, dtype=torch.bfloat16) * 0.05)(D, D)),
        }
    _A_in = _A_setup()

    def _B_setup():
        B, S, D = 1, 2048, 512
        return {
            "x": _w((lambda *s: torch.randn(*s, dtype=torch.bfloat16) * 0.05)(B, S, D)),
            "wqkv": _w((lambda *s: torch.randn(*s, dtype=torch.bfloat16) * 0.1)(D, 3 * D)),
            "wo": _w((lambda *s: torch.randn(*s, dtype=torch.bfloat16) * 0.05)(D, D)),
        }
    _B_in = _B_setup()

    return {
        "A_x": _A_in["x"],
        "A_wqkv": _A_in["wqkv"],
        "A_w_phi": _A_in["w_phi"],
        "A_wo": _A_in["wo"],
        "B_x": _B_in["x"],
        "B_wqkv": _B_in["wqkv"],
        "B_wo": _B_in["wo"],
    }

def reference(A_x, A_wqkv, A_w_phi, A_wo, B_x, B_wqkv, B_wo):
    def _A_ref(x, wqkv, w_phi, wo):
        B, S, D = x.shape
        H = 32; Dh = D // H
        qkv = (lambda x, *d: x.permute(*d))((x @ wqkv).reshape(B, S, 3, H, Dh), 2, 0, 3, 1, 4)
        q, k, v = qkv[0], qkv[1], qkv[2]
        pq = torch.einsum("bhsd,hdf->bhsf", q, w_phi)
        pk = torch.einsum("bhsd,hdf->bhsf", k, w_phi)
        phi_q = torch.concatenate([_softmax(pq, axis=-1), _softmax(-pq, axis=-1)], axis=-1)
        phi_k = torch.concatenate([_softmax(pk, axis=-1), _softmax(-pk, axis=-1)], axis=-1)
        kv = torch.einsum("bhsf,bhsd->bhfd", phi_k, v)
        z  = torch.einsum("bhsf->bhf", phi_k)
        num = torch.einsum("bhqf,bhfd->bhqd", phi_q, kv)
        den = torch.einsum("bhqf,bhf->bhq", phi_q, z)[..., None] + 1e-6
        o = num / den
        return (lambda x, *d: x.permute(*d))(o, 0, 2, 1, 3).reshape(B, S, D) @ wo

    def _B_ref(x, wqkv, wo):
        B, S, D = x.shape
        H = 32; Dh = D // H
        W, dil = 8, 2
        qkv = (lambda x, *d: x.permute(*d))((x @ wqkv).reshape(B, S, 3, H, Dh), 2, 0, 3, 1, 4)
        q, k, v = qkv[0], qkv[1], qkv[2]
        scale = Dh ** -0.5
        pos = torch.arange(S)
        off = torch.arange(W) * dil
        idx = pos[:, None] - off[None, :]
        mask = idx >= 0
        idx_c = torch.where(mask, idx, 0).reshape(-1)
        kg = k[:, :, idx_c, :].reshape(B, H, S, W, Dh)
        vg = v[:, :, idx_c, :].reshape(B, H, S, W, Dh)
        logits = torch.einsum("bhsd,bhswd->bhsw", q, kg) * scale
        logits = torch.where(mask[None, None, :, :], logits, -1e9)
        attn = _softmax(logits, axis=-1)
        o = torch.einsum("bhsw,bhswd->bhsd", attn, vg)
        return (lambda x, *d: x.permute(*d))(o, 0, 2, 1, 3).reshape(B, S, D) @ wo

    x = A_x
    x = x + _A_ref(_layernorm(x, axis=-1), A_wqkv, A_w_phi, A_wo)
    x = x + _B_ref(_layernorm(x, axis=-1), B_wqkv, B_wo)
    x = x + _A_ref(_layernorm(x, axis=-1), A_wqkv, A_w_phi, A_wo)
    x = x + _B_ref(_layernorm(x, axis=-1), B_wqkv, B_wo)
    return x
```

```asm
; @launch grid=(256,1,1) block=(512,1,1) lds=163840
.amdgcn_target "amdgcn-amd-amdhsa--gfx950"
.text
.globl interleave_layers__linear_kernel_hedgehog__sliding_local_dilated__prompt_kernel
.p2align 8
.type interleave_layers__linear_kernel_hedgehog__sliding_local_dilated__prompt_kernel,@function
interleave_layers__linear_kernel_hedgehog__sliding_local_dilated__prompt_kernel:
    s_cmp_ge_u32 s2, 256
    s_cbranch_scc1 L_end
    s_load_dwordx16 s[80:95], s[0:1], 0
    s_load_dwordx4 s[96:99], s[0:1], 64
    s_getpc_b64 s[48:49]
L_pc:
    s_sub_u32 s48, s48, L_pc-interleave_layers__linear_kernel_hedgehog__sliding_local_dilated__prompt_kernel
    s_subb_u32 s49, s49, 0
    s_and_b32 s49, s49, 0xffff
    s_mov_b32 s50, L_codeend-interleave_layers__linear_kernel_hedgehog__sliding_local_dilated__prompt_kernel
    s_mov_b32 s51, 0x00020000
    v_and_b32 v1, 127, v0
    v_lshlrev_b32 v1, 4, v1
    s_lshr_b32 s74, s2, 3
    s_lshl_b32 s73, s74, 11
    buffer_load_dwordx4 v[240:243], v1, s[48:51], s73 offen
    v_lshrrev_b32 v1, 6, v0
    s_nop 0
    v_readfirstlane_b32 s3, v1
    v_and_b32 v1, 63, v0
    s_and_b32 s73, s2, 7
    s_lshr_b32 s74, s2, 3
    s_lshl_b32 s4, s73, 1
    s_lshr_b32 s73, s74, 4
    s_add_u32 s4, s4, s73
    s_and_b32 s5, s74, 15
    s_lshr_b32 s6, s5, 3
    s_and_b32 s7, s5, 7
    s_and_b32 s72, s3, 3
    s_mov_b32 s52, 0
    s_mov_b32 s53, 1
    s_mov_b32 s55, 4
    s_mov_b32 s46, 4
    s_mov_b32 s79, 0
    v_mov_b32 v10, 163328
    v_mov_b32 v11, 1
    s_waitcnt lgkmcnt(0)
    s_mov_b32 s8, s80
    s_and_b32 s9, s81, 0xffff
    s_mov_b32 s10, 2097152
    s_mov_b32 s11, 0x00020000
    s_mov_b32 s12, s82
    s_and_b32 s13, s83, 0xffff
    s_mov_b32 s14, 1572864
    s_mov_b32 s15, 0x00020000
    s_mov_b32 s16, s84
    s_and_b32 s17, s85, 0xffff
    s_mov_b32 s18, 16384
    s_mov_b32 s19, 0x00020000
    s_mov_b32 s20, s86
    s_and_b32 s21, s87, 0xffff
    s_mov_b32 s22, 524288
    s_mov_b32 s23, 0x00020000
    s_mov_b32 s24, s90
    s_and_b32 s25, s91, 0xffff
    s_mov_b32 s26, 1572864
    s_mov_b32 s27, 0x00020000
    s_mov_b32 s28, s92
    s_and_b32 s29, s93, 0xffff
    s_mov_b32 s30, 524288
    s_mov_b32 s31, 0x00020000
    s_mov_b32 s32, s94
    s_and_b32 s33, s95, 0xffff
    s_mov_b32 s34, 2097152
    s_mov_b32 s35, 0x00020000
    s_mov_b32 s36, s96
    s_and_b32 s37, s97, 0xffff
    s_mov_b32 s38, 256
    s_mov_b32 s39, 0x00020000
    s_mov_b32 s40, s98
    s_and_b32 s41, s99, 0xffff
    s_mov_b32 s42, 268435456
    s_mov_b32 s43, 0x00020000
    s_cmp_lt_u32 s3, 4
    s_cbranch_scc1 L_compute
L_helper:
    s_cmp_lg_u32 s72, 3
    s_cbranch_scc1 L_non_skip
    s_memrealtime s[100:101]
    s_waitcnt lgkmcnt(0)
    s_lshl_b32 s100, s100, 4
    s_or_b32 s100, s100, 0x80000000
    v_mov_b32 v252, s100
    v_mov_b32 v253, 0
    v_mov_b32 v254, s100
    s_lshl_b32 s75, s4, 4
    s_mov_b64 exec, 1
    buffer_atomic_cmpswap v[252:253], off, s[36:39], s75 sc0 sc1
    s_mov_b64 exec, -1
L_non_skip:
    s_lshl_b32 s73, s4, 21
    s_lshl_b32 s74, s72, 12
    s_add_u32 s73, s73, s74
    s_add_u32 s73, s73, 1081344
    v_and_b32 v8, 31, v1
    v_lshlrev_b32 v8, 7, v8
    buffer_load_dword v248, v8, s[40:43], s73 offen sc1
    s_lshl_b32 s73, s5, 2
    s_add_u32 s73, s73, s72
    s_lshl_b32 s73, s73, 11
    s_add_u32 s73, s73, 34865152
    v_and_b32 v8, 15, v1
    v_lshlrev_b32 v8, 7, v8
    buffer_load_dword v249, v8, s[40:43], s73 offen sc1
    v_mov_b32 v8, 0
    v_lshl_add_u32 v9, v1, 2, v10
    ds_write_b32 v9, v8
    s_waitcnt lgkmcnt(0)
    s_barrier
    s_cmp_lg_u32 s72, 3
    s_cbranch_scc1 L_non_skip2
    s_waitcnt vmcnt(2)
    v_cmp_eq_u32 vcc, 0, v252
    s_nop 1
    v_cndmask_b32 v252, v252, v254, vcc
    s_mov_b64 exec, 1
    ds_write_b32 v10, v252 offset:76
    s_mov_b64 exec, -1
L_non_skip2:
    s_lshr_b32 s73, s2, 3
    s_lshl_b32 s73, s73, 2
    s_add_u32 s73, s73, s72
    s_mul_i32 s54, s73, 12288
    v_lshlrev_b32 v28, 4, v1
    buffer_load_dwordx4 v[224:227], v28, s[12:15], s54 offen offset:0
    buffer_load_dwordx4 v[228:231], v28, s[12:15], s54 offen offset:1024
    buffer_load_dwordx4 v[232:235], v28, s[12:15], s54 offen offset:2048
    buffer_load_dwordx4 v[236:239], v28, s[12:15], s54 offen offset:3072
    s_add_u32 s54, s54, 4096
    buffer_load_dwordx4 v[224:227], v28, s[12:15], s54 offen offset:0
    buffer_load_dwordx4 v[228:231], v28, s[12:15], s54 offen offset:1024
    buffer_load_dwordx4 v[232:235], v28, s[12:15], s54 offen offset:2048
    buffer_load_dwordx4 v[236:239], v28, s[12:15], s54 offen offset:3072
    s_add_u32 s54, s54, 4096
    buffer_load_dwordx4 v[224:227], v28, s[12:15], s54 offen offset:0
    buffer_load_dwordx4 v[228:231], v28, s[12:15], s54 offen offset:1024
    buffer_load_dwordx4 v[232:235], v28, s[12:15], s54 offen offset:2048
    buffer_load_dwordx4 v[236:239], v28, s[12:15], s54 offen offset:3072
    s_lshl_b32 s78, s72, 10
    s_mul_i32 s73, s72, 49152
    s_lshl_b32 s74, s5, 6
    s_add_u32 s73, s73, s74
    v_bfe_u32 v2, v1, 2, 4
    v_mul_u32_u24 v2, 3072, v2
    v_and_b32 v8, 3, v1
    v_lshl_add_u32 v2, v8, 4, v2
    v_add_u32 v2, s73, v2
    v_and_b32 v27, 63, v1
    v_lshlrev_b32 v27, 4, v27
    v_add_u32 v27, s78, v27
    s_mov_b32 s54, 0
    buffer_load_dwordx4 v[32:35], v2, s[12:15], s54 offen
    s_mov_b32 s54, 1024
    buffer_load_dwordx4 v[36:39], v2, s[12:15], s54 offen
    s_mov_b32 s54, 2048
    buffer_load_dwordx4 v[40:43], v2, s[12:15], s54 offen
    s_mov_b32 s54, 196608
    buffer_load_dwordx4 v[44:47], v2, s[12:15], s54 offen
    s_mov_b32 s54, 197632
    buffer_load_dwordx4 v[48:51], v2, s[12:15], s54 offen
    s_mov_b32 s54, 198656
    buffer_load_dwordx4 v[52:55], v2, s[12:15], s54 offen
    s_mov_b32 s54, 393216
    buffer_load_dwordx4 v[56:59], v2, s[12:15], s54 offen
    s_mov_b32 s54, 394240
    buffer_load_dwordx4 v[60:63], v2, s[12:15], s54 offen
    s_mov_b32 s54, 395264
    buffer_load_dwordx4 v[64:67], v2, s[12:15], s54 offen
    s_mov_b32 s54, 589824
    buffer_load_dwordx4 v[68:71], v2, s[12:15], s54 offen
    s_mov_b32 s54, 590848
    buffer_load_dwordx4 v[72:75], v2, s[12:15], s54 offen
    s_mov_b32 s54, 591872
    buffer_load_dwordx4 v[76:79], v2, s[12:15], s54 offen
    v_add_u32 v9, 61440, v27
    v_bfe_u32 v28, v1, 1, 2
    v_bfe_u32 v8, v1, 4, 2
    v_xor_b32 v28, v28, v8
    s_lshl_b32 s73, s72, 13
    s_lshl_b32 s74, s7, 7
    s_add_u32 s73, s73, s74
    v_bfe_u32 v3, v1, 3, 3
    v_lshlrev_b32 v3, 10, v3
    v_and_b32 v8, 1, v1
    v_lshl_add_u32 v3, v8, 4, v3
    v_add_u32 v3, s73, v3
    v_lshl_add_u32 v3, v28, 5, v3
    s_add_u32 s73, s72, 0
    s_lshr_b32 s74, s73, 1
    s_lshl_b32 s74, s74, 12
    s_and_b32 s75, s73, 1
    s_lshl_b32 s75, s75, 5
    s_add_u32 s74, s74, s75
    v_bfe_u32 v4, v1, 4, 2
    v_lshlrev_b32 v4, 9, v4
    v_bfe_u32 v8, v1, 2, 2
    v_lshl_add_u32 v4, v8, 6, v4
    v_and_b32 v8, 3, v1
    v_lshl_add_u32 v4, v8, 3, v4
    v_add_u32 v4, s74, v4
    v_add_u32 v5, 61440, v4
    s_lshl_b32 s73, s73, 6
    v_and_b32 v20, 15, v1
    v_lshlrev_b32 v20, 2, v20
    v_add_u32 v20, 159744, v20
    v_add_u32 v20, s73, v20
    s_add_u32 s73, s72, 4
    s_lshr_b32 s74, s73, 1
    s_lshl_b32 s74, s74, 12
    s_and_b32 s75, s73, 1
    s_lshl_b32 s75, s75, 5
    s_add_u32 s74, s74, s75
    v_bfe_u32 v6, v1, 4, 2
    v_lshlrev_b32 v6, 9, v6
    v_bfe_u32 v8, v1, 2, 2
    v_lshl_add_u32 v6, v8, 6, v6
    v_and_b32 v8, 3, v1
    v_lshl_add_u32 v6, v8, 3, v6
    v_add_u32 v6, s74, v6
    v_add_u32 v7, 61440, v6
    s_lshl_b32 s73, s73, 6
    v_and_b32 v21, 15, v1
    v_lshlrev_b32 v21, 2, v21
    v_add_u32 v21, 159744, v21
    v_add_u32 v21, s73, v21
    v_mov_b32 v12, 0x3f803f80
    v_mov_b32 v13, 0x3f803f80
    v_mov_b32 v14, 0x3f803f80
    v_mov_b32 v15, 0x3f803f80
    s_lshl_b32 s73, s72, 9
    s_lshl_b32 s74, s4, 2
    s_add_u32 s75, s74, s72
    s_lshr_b32 s76, s75, 2
    s_lshl_b32 s76, s76, 21
    s_and_b32 s100, s75, 3
    s_lshl_b32 s100, s100, 11
    s_add_u32 s76, s76, s100
    v_bfe_u32 v23, v1, 5, 1
    v_lshlrev_b32 v23, 10, v23
    v_bfe_u32 v8, v1, 4, 1
    v_lshl_add_u32 v23, v8, 7, v23
    v_and_b32 v8, 15, v1
    v_lshl_add_u32 v23, v8, 3, v23
    v_add_u32 v23, s76, v23
    s_sub_u32 s75, s74, 1
    s_cmp_eq_u32 s4, 0
    s_cselect_b32 s75, 0, s75
    s_lshr_b32 s74, s75, 2
    s_lshl_b32 s74, s74, 21
    s_and_b32 s100, s75, 3
    s_lshl_b32 s100, s100, 11
    s_add_u32 s74, s74, s100
    v_and_b32 v22, 7, v1
    v_lshlrev_b32 v22, 8, v22
    v_add_u32 v22, 1081472, v22
    v_add_u32 v22, s74, v22
    v_bfe_u32 v24, v1, 5, 1
    v_lshlrev_b32 v24, 10, v24
    v_and_b32 v8, 15, v1
    v_lshl_add_u32 v24, v8, 3, v24
    v_add_u32 v24, 128, v24
    v_add_u32 v24, s74, v24
    v_and_b32 v25, 31, v1
    v_lshlrev_b32 v25, 4, v25
    v_add_u32 v25, 160768, v25
    v_add_u32 v25, s73, v25
    v_and_b32 v26, 15, v1
    v_lshlrev_b32 v26, 4, v26
    v_add_u32 v26, 160512, v26
    s_mov_b32 s44, 1048576
    s_mov_b32 s54, 786432
    buffer_load_dwordx4 v[80:83], v2, s[12:15], s54 offen
    s_mov_b32 s54, 787456
    buffer_load_dwordx4 v[84:87], v2, s[12:15], s54 offen
    s_mov_b32 s54, 788480
    buffer_load_dwordx4 v[88:91], v2, s[12:15], s54 offen
    s_waitcnt vmcnt(12)
    ds_write_b128 v27, v[32:35] offset:0
    ds_write_b128 v27, v[36:39] offset:4096
    ds_write_b128 v27, v[40:43] offset:8192
    s_mov_b64 exec, 1
    ds_add_u32 v10, v11 offset:0
    s_mov_b64 exec, -1
    s_mov_b32 s54, 983040
    buffer_load_dwordx4 v[92:95], v2, s[12:15], s54 offen
    s_mov_b32 s54, 984064
    buffer_load_dwordx4 v[96:99], v2, s[12:15], s54 offen
    s_mov_b32 s54, 985088
    buffer_load_dwordx4 v[100:103], v2, s[12:15], s54 offen
    s_waitcnt vmcnt(12)
    ds_write_b128 v27, v[44:47] offset:12288
    ds_write_b128 v27, v[48:51] offset:16384
    ds_write_b128 v27, v[52:55] offset:20480
    s_mov_b64 exec, 1
    ds_add_u32 v10, v11 offset:4
    s_mov_b64 exec, -1
    s_mov_b32 s56, 4000000
L_lw1:
    ds_read_b32 v8, v10 offset:0
    s_waitcnt lgkmcnt(0)
    v_readfirstlane_b32 s76, v8
    s_nop 0
    s_cmp_ge_u32 s76, s55
    s_cbranch_scc1 L_lwd1
    s_sleep 1
    s_sub_u32 s56, s56, 1
    s_cbranch_scc0 L_lw1
L_lwd1:
    ds_read_b64_tr_b16 v[224:225], v4 offset:0
    ds_read_b64_tr_b16 v[226:227], v4 offset:256
    ds_read_b64_tr_b16 v[228:229], v4 offset:2048
    ds_read_b64_tr_b16 v[230:231], v4 offset:2304
    s_waitcnt lgkmcnt(2)
    v_mfma_f32_16x16x32_bf16 v[240:243], v[12:15], v[224:227], 0
    s_waitcnt lgkmcnt(0)
    v_mfma_f32_16x16x32_bf16 v[240:243], v[12:15], v[228:231], v[240:243]
    s_cmp_ge_u32 s72, 2
    s_cbranch_scc1 L_cs2
    ds_read_b64_tr_b16 v[232:233], v6 offset:0
    ds_read_b64_tr_b16 v[234:235], v6 offset:256
    ds_read_b64_tr_b16 v[236:237], v6 offset:2048
    ds_read_b64_tr_b16 v[238:239], v6 offset:2304
    s_waitcnt lgkmcnt(2)
    v_mfma_f32_16x16x32_bf16 v[244:247], v[12:15], v[232:235], 0
    s_waitcnt lgkmcnt(0)
    v_mfma_f32_16x16x32_bf16 v[244:247], v[12:15], v[236:239], v[244:247]
L_cs2:
    s_mov_b32 s54, 1179648
    buffer_load_dwordx4 v[104:107], v2, s[12:15], s54 offen
    s_mov_b32 s54, 1180672
    buffer_load_dwordx4 v[108:111], v2, s[12:15], s54 offen
    s_mov_b32 s54, 1181696
    buffer_load_dwordx4 v[112:115], v2, s[12:15], s54 offen
    s_waitcnt vmcnt(12)
    ds_write_b128 v27, v[56:59] offset:24576
    ds_write_b128 v27, v[60:63] offset:28672
    ds_write_b128 v27, v[64:67] offset:32768
    s_mov_b64 exec, 1
    ds_add_u32 v10, v11 offset:8
    s_mov_b64 exec, -1
    s_mov_b32 s56, 4000000
L_lw3:
    ds_read_b32 v8, v10 offset:4
    s_waitcnt lgkmcnt(0)
    v_readfirstlane_b32 s76, v8
    s_nop 0
    s_cmp_ge_u32 s76, s55
    s_cbranch_scc1 L_lwd3
    s_sleep 1
    s_sub_u32 s56, s56, 1
    s_cbranch_scc0 L_lw3
L_lwd3:
    ds_read_b64_tr_b16 v[224:225], v4 offset:12288
    ds_read_b64_tr_b16 v[226:227], v4 offset:12544
    ds_read_b64_tr_b16 v[228:229], v4 offset:14336
    ds_read_b64_tr_b16 v[230:231], v4 offset:14592
    s_waitcnt lgkmcnt(2)
    v_mfma_f32_16x16x32_bf16 v[240:243], v[12:15], v[224:227], v[240:243]
    s_waitcnt lgkmcnt(0)
    v_mfma_f32_16x16x32_bf16 v[240:243], v[12:15], v[228:231], v[240:243]
    s_cmp_ge_u32 s72, 2
    s_cbranch_scc1 L_cs4
    ds_read_b64_tr_b16 v[232:233], v6 offset:12288
    ds_read_b64_tr_b16 v[234:235], v6 offset:12544
    ds_read_b64_tr_b16 v[236:237], v6 offset:14336
    ds_read_b64_tr_b16 v[238:239], v6 offset:14592
    s_waitcnt lgkmcnt(2)
    v_mfma_f32_16x16x32_bf16 v[244:247], v[12:15], v[232:235], v[244:247]
    s_waitcnt lgkmcnt(0)
    v_mfma_f32_16x16x32_bf16 v[244:247], v[12:15], v[236:239], v[244:247]
L_cs4:
    s_mov_b32 s54, 1376256
    buffer_load_dwordx4 v[116:119], v2, s[12:15], s54 offen
    s_mov_b32 s54, 1377280
    buffer_load_dwordx4 v[120:123], v2, s[12:15], s54 offen
    s_mov_b32 s54, 1378304
    buffer_load_dwordx4 v[124:127], v2, s[12:15], s54 offen
    s_waitcnt vmcnt(12)
    ds_write_b128 v27, v[68:71] offset:36864
    ds_write_b128 v27, v[72:75] offset:40960
    ds_write_b128 v27, v[76:79] offset:45056
    s_mov_b64 exec, 1
    ds_add_u32 v10, v11 offset:12
    s_mov_b64 exec, -1
    s_mov_b32 s56, 4000000
L_lw5:
    ds_read_b32 v8, v10 offset:8
    s_waitcnt lgkmcnt(0)
    v_readfirstlane_b32 s76, v8
    s_nop 0
    s_cmp_ge_u32 s76, s55
    s_cbranch_scc1 L_lwd5
    s_sleep 1
    s_sub_u32 s56, s56, 1
    s_cbranch_scc0 L_lw5
L_lwd5:
    ds_read_b64_tr_b16 v[224:225], v4 offset:24576
    ds_read_b64_tr_b16 v[226:227], v4 offset:24832
    ds_read_b64_tr_b16 v[228:229], v4 offset:26624
    ds_read_b64_tr_b16 v[230:231], v4 offset:26880
    s_waitcnt lgkmcnt(2)
    v_mfma_f32_16x16x32_bf16 v[240:243], v[12:15], v[224:227], v[240:243]
    s_waitcnt lgkmcnt(0)
    v_mfma_f32_16x16x32_bf16 v[240:243], v[12:15], v[228:231], v[240:243]
    s_cmp_ge_u32 s72, 2
    s_cbranch_scc1 L_cs6
    ds_read_b64_tr_b16 v[232:233], v6 offset:24576
    ds_read_b64_tr_b16 v[234:235], v6 offset:24832
    ds_read_b64_tr_b16 v[236:237], v6 offset:26624
    ds_read_b64_tr_b16 v[238:239], v6 offset:26880
    s_waitcnt lgkmcnt(2)
    v_mfma_f32_16x16x32_bf16 v[244:247], v[12:15], v[232:235], v[244:247]
    s_waitcnt lgkmcnt(0)
    v_mfma_f32_16x16x32_bf16 v[244:247], v[12:15], v[236:239], v[244:247]
L_cs6:
    s_waitcnt vmcnt(9)
    ds_write_b128 v27, v[80:83] offset:49152
    ds_write_b128 v27, v[84:87] offset:53248
    ds_write_b128 v27, v[88:91] offset:57344
    s_mov_b64 exec, 1
    ds_add_u32 v10, v11 offset:16
    s_mov_b64 exec, -1
    s_mov_b32 s56, 4000000
L_lw7:
    ds_read_b32 v8, v10 offset:12
    s_waitcnt lgkmcnt(0)
    v_readfirstlane_b32 s76, v8
    s_nop 0
    s_cmp_ge_u32 s76, s55
    s_cbranch_scc1 L_lwd7
    s_sleep 1
    s_sub_u32 s56, s56, 1
    s_cbranch_scc0 L_lw7
L_lwd7:
    ds_read_b64_tr_b16 v[224:225], v4 offset:36864
    ds_read_b64_tr_b16 v[226:227], v4 offset:37120
    ds_read_b64_tr_b16 v[228:229], v4 offset:38912
    ds_read_b64_tr_b16 v[230:231], v4 offset:39168
    s_waitcnt lgkmcnt(2)
    v_mfma_f32_16x16x32_bf16 v[240:243], v[12:15], v[224:227], v[240:243]
    s_waitcnt lgkmcnt(0)
    v_mfma_f32_16x16x32_bf16 v[240:243], v[12:15], v[228:231], v[240:243]
    s_cmp_ge_u32 s72, 2
    s_cbranch_scc1 L_cs8
    ds_read_b64_tr_b16 v[232:233], v6 offset:36864
    ds_read_b64_tr_b16 v[234:235], v6 offset:37120
    ds_read_b64_tr_b16 v[236:237], v6 offset:38912
    ds_read_b64_tr_b16 v[238:239], v6 offset:39168
    s_waitcnt lgkmcnt(2)
    v_mfma_f32_16x16x32_bf16 v[244:247], v[12:15], v[232:235], v[244:247]
    s_waitcnt lgkmcnt(0)
    v_mfma_f32_16x16x32_bf16 v[244:247], v[12:15], v[236:239], v[244:247]
L_cs8:
    s_waitcnt vmcnt(6)
    ds_write_b128 v9, v[92:95] offset:0
    ds_write_b128 v9, v[96:99] offset:4096
    ds_write_b128 v9, v[100:103] offset:8192
    s_mov_b64 exec, 1
    ds_add_u32 v10, v11 offset:20
    s_mov_b64 exec, -1
    s_mov_b32 s56, 4000000
L_lw9:
    ds_read_b32 v8, v10 offset:16
    s_waitcnt lgkmcnt(0)
    v_readfirstlane_b32 s76, v8
    s_nop 0
    s_cmp_ge_u32 s76, s55
    s_cbranch_scc1 L_lwd9
    s_sleep 1
    s_sub_u32 s56, s56, 1
    s_cbranch_scc0 L_lw9
L_lwd9:
    ds_read_b64_tr_b16 v[224:225], v4 offset:49152
    ds_read_b64_tr_b16 v[226:227], v4 offset:49408
    ds_read_b64_tr_b16 v[228:229], v4 offset:51200
    ds_read_b64_tr_b16 v[230:231], v4 offset:51456
    s_waitcnt lgkmcnt(2)
    v_mfma_f32_16x16x32_bf16 v[240:243], v[12:15], v[224:227], v[240:243]
    s_waitcnt lgkmcnt(0)
    v_mfma_f32_16x16x32_bf16 v[240:243], v[12:15], v[228:231], v[240:243]
    s_cmp_ge_u32 s72, 2
    s_cbranch_scc1 L_cs10
    ds_read_b64_tr_b16 v[232:233], v6 offset:49152
    ds_read_b64_tr_b16 v[234:235], v6 offset:49408
    ds_read_b64_tr_b16 v[236:237], v6 offset:51200
    ds_read_b64_tr_b16 v[238:239], v6 offset:51456
    s_waitcnt lgkmcnt(2)
    v_mfma_f32_16x16x32_bf16 v[244:247], v[12:15], v[232:235], v[244:247]
    s_waitcnt lgkmcnt(0)
    v_mfma_f32_16x16x32_bf16 v[244:247], v[12:15], v[236:239], v[244:247]
L_cs10:
    s_mov_b32 s56, 4000000
L_lw11:
    ds_read_b32 v8, v10 offset:48
    s_waitcnt lgkmcnt(0)
    v_readfirstlane_b32 s76, v8
    s_nop 0
    s_cmp_ge_u32 s76, s55
    s_cbranch_scc1 L_lwd11
    s_sleep 1
    s_sub_u32 s56, s56, 1
    s_cbranch_scc0 L_lw11
L_lwd11:
    buffer_load_dwordx2 v[248:249], v23, s[40:43], s44 offen offset:0
    buffer_load_dwordx2 v[250:251], v23, s[40:43], s44 offen offset:256
    buffer_load_dwordx2 v[252:253], v23, s[40:43], s44 offen offset:512
    buffer_load_dwordx2 v[254:255], v23, s[40:43], s44 offen offset:768
    s_waitcnt vmcnt(7)
    ds_write_b128 v9, v[104:107] offset:12288
    ds_write_b128 v9, v[108:111] offset:16384
    ds_write_b128 v9, v[112:115] offset:20480
    s_mov_b64 exec, 1
    ds_add_u32 v10, v11 offset:24
    s_mov_b64 exec, -1
    s_mov_b32 s56, 4000000
L_lw12:
    ds_read_b32 v8, v10 offset:20
    s_waitcnt lgkmcnt(0)
    v_readfirstlane_b32 s76, v8
    s_nop 0
    s_cmp_ge_u32 s76, s55
    s_cbranch_scc1 L_lwd12
    s_sleep 1
    s_sub_u32 s56, s56, 1
    s_cbranch_scc0 L_lw12
L_lwd12:
    ds_read_b64_tr_b16 v[224:225], v5 offset:0
    ds_read_b64_tr_b16 v[226:227], v5 offset:256
    ds_read_b64_tr_b16 v[228:229], v5 offset:2048
    ds_read_b64_tr_b16 v[230:231], v5 offset:2304
    s_waitcnt lgkmcnt(2)
    v_mfma_f32_16x16x32_bf16 v[240:243], v[12:15], v[224:227], v[240:243]
    s_waitcnt lgkmcnt(0)
    v_mfma_f32_16x16x32_bf16 v[240:243], v[12:15], v[228:231], v[240:243]
    s_cmp_ge_u32 s72, 2
    s_cbranch_scc1 L_cs13
    ds_read_b64_tr_b16 v[232:233], v7 offset:0
    ds_read_b64_tr_b16 v[234:235], v7 offset:256
    ds_read_b64_tr_b16 v[236:237], v7 offset:2048
    ds_read_b64_tr_b16 v[238:239], v7 offset:2304
    s_waitcnt lgkmcnt(2)
    v_mfma_f32_16x16x32_bf16 v[244:247], v[12:15], v[232:235], v[244:247]
    s_waitcnt lgkmcnt(0)
    v_mfma_f32_16x16x32_bf16 v[244:247], v[12:15], v[236:239], v[244:247]
L_cs13:
    s_waitcnt vmcnt(4)
    ds_write_b128 v9, v[116:119] offset:24576
    ds_write_b128 v9, v[120:123] offset:28672
    ds_write_b128 v9, v[124:127] offset:32768
    s_mov_b64 exec, 1
    ds_add_u32 v10, v11 offset:28
    s_mov_b64 exec, -1
    s_mov_b32 s56, 4000000
L_lw14:
    ds_read_b32 v8, v10 offset:24
    s_waitcnt lgkmcnt(0)
    v_readfirstlane_b32 s76, v8
    s_nop 0
    s_cmp_ge_u32 s76, s55
    s_cbranch_scc1 L_lwd14
    s_sleep 1
    s_sub_u32 s56, s56, 1
    s_cbranch_scc0 L_lw14
L_lwd14:
    ds_read_b64_tr_b16 v[224:225], v5 offset:12288
    ds_read_b64_tr_b16 v[226:227], v5 offset:12544
    ds_read_b64_tr_b16 v[228:229], v5 offset:14336
    ds_read_b64_tr_b16 v[230:231], v5 offset:14592
    s_waitcnt lgkmcnt(2)
    v_mfma_f32_16x16x32_bf16 v[240:243], v[12:15], v[224:227], v[240:243]
    s_waitcnt lgkmcnt(0)
    v_mfma_f32_16x16x32_bf16 v[240:243], v[12:15], v[228:231], v[240:243]
    s_cmp_ge_u32 s72, 2
    s_cbranch_scc1 L_cs15
    ds_read_b64_tr_b16 v[232:233], v7 offset:12288
    ds_read_b64_tr_b16 v[234:235], v7 offset:12544
    ds_read_b64_tr_b16 v[236:237], v7 offset:14336
    ds_read_b64_tr_b16 v[238:239], v7 offset:14592
    s_waitcnt lgkmcnt(2)
    v_mfma_f32_16x16x32_bf16 v[244:247], v[12:15], v[232:235], v[244:247]
    s_waitcnt lgkmcnt(0)
    v_mfma_f32_16x16x32_bf16 v[244:247], v[12:15], v[236:239], v[244:247]
L_cs15:
    s_mov_b32 s56, 4000000
L_lw16:
    ds_read_b32 v8, v10 offset:28
    s_waitcnt lgkmcnt(0)
    v_readfirstlane_b32 s76, v8
    s_nop 0
    s_cmp_ge_u32 s76, s55
    s_cbranch_scc1 L_lwd16
    s_sleep 1
    s_sub_u32 s56, s56, 1
    s_cbranch_scc0 L_lw16
L_lwd16:
    ds_read_b64_tr_b16 v[224:225], v5 offset:24576
    ds_read_b64_tr_b16 v[226:227], v5 offset:24832
    ds_read_b64_tr_b16 v[228:229], v5 offset:26624
    ds_read_b64_tr_b16 v[230:231], v5 offset:26880
    s_waitcnt lgkmcnt(2)
    v_mfma_f32_16x16x32_bf16 v[240:243], v[12:15], v[224:227], v[240:243]
    s_waitcnt lgkmcnt(0)
    v_mfma_f32_16x16x32_bf16 v[240:243], v[12:15], v[228:231], v[240:243]
    s_cmp_ge_u32 s72, 2
    s_cbranch_scc1 L_cs17
    ds_read_b64_tr_b16 v[232:233], v7 offset:24576
    ds_read_b64_tr_b16 v[234:235], v7 offset:24832
    ds_read_b64_tr_b16 v[236:237], v7 offset:26624
    ds_read_b64_tr_b16 v[238:239], v7 offset:26880
    s_waitcnt lgkmcnt(2)
    v_mfma_f32_16x16x32_bf16 v[244:247], v[12:15], v[232:235], v[244:247]
    s_waitcnt lgkmcnt(0)
    v_mfma_f32_16x16x32_bf16 v[244:247], v[12:15], v[236:239], v[244:247]
L_cs17:
    s_nop 7
    s_nop 1
    v_mov_b32 v16, v240
    v_mov_b32 v17, v244
    s_branch L_H_loop
L_compute:
    s_setprio 2
    s_barrier
    s_lshl_b32 s73, s4, 1
    s_add_u32 s73, s73, s6
    s_lshl_b32 s73, s73, 2
    s_add_u32 s73, s73, s72
    s_lshl_b32 s74, s73, 14
    s_lshl_b32 s75, s7, 7
    s_add_u32 s74, s74, s75
    v_and_b32 v254, 15, v1
    v_lshlrev_b32 v254, 10, v254
    v_bfe_u32 v15, v1, 4, 2
    v_lshl_add_u32 v254, v15, 3, v254
    v_add_u32 v254, s74, v254
    buffer_load_dwordx2 v[80:81], v254, s[8:11], 0 offen offset:0
    buffer_load_dwordx2 v[82:83], v254, s[8:11], 0 offen offset:32
    buffer_load_dwordx2 v[84:85], v254, s[8:11], 0 offen offset:64
    buffer_load_dwordx2 v[86:87], v254, s[8:11], 0 offen offset:96
    v_bfe_u32 v148, v1, 2, 1
    v_lshlrev_b32 v148, 9, v148
    v_bfe_u32 v15, v1, 3, 2
    v_lshl_add_u32 v148, v15, 3, v148
    v_and_b32 v15, 3, v1
    v_lshl_add_u32 v148, v15, 1, v148
    v_bfe_u32 v15, v1, 5, 1
    v_lshl_add_u32 v148, v15, 7, v148
    s_lshl_b32 s75, s5, 10
    buffer_load_ushort v52, v148, s[16:19], s75 offen offset:0
    buffer_load_ushort v53, v148, s[16:19], s75 offen offset:32
    buffer_load_ushort v54, v148, s[16:19], s75 offen offset:64
    buffer_load_ushort v55, v148, s[16:19], s75 offen offset:96
    buffer_load_ushort v56, v148, s[16:19], s75 offen offset:256
    buffer_load_ushort v57, v148, s[16:19], s75 offen offset:288
    buffer_load_ushort v58, v148, s[16:19], s75 offen offset:320
    buffer_load_ushort v59, v148, s[16:19], s75 offen offset:352
    s_lshr_b32 s47, s73, 3
    s_lshl_b32 s47, s47, 21
    s_and_b32 s100, s73, 7
    s_lshl_b32 s100, s100, 14
    s_add_u32 s47, s47, s100
    s_lshr_b32 s74, s73, 1
    s_lshr_b32 s61, s74, 2
    s_lshl_b32 s61, s61, 21
    s_and_b32 s100, s74, 3
    s_lshl_b32 s100, s100, 11
    s_add_u32 s61, s61, s100
    s_lshl_b32 s75, s7, 1
    s_and_b32 s76, s72, 1
    s_add_u32 s75, s75, s76
    s_lshl_b32 s75, s75, 7
    s_add_u32 s61, s61, s75
    s_add_u32 s61, s61, 1081344
    s_lshr_b32 s75, s74, 2
    s_lshl_b32 s75, s75, 21
    s_and_b32 s100, s74, 3
    s_lshl_b32 s100, s100, 15
    s_add_u32 s75, s75, s100
    s_lshl_b32 s54, s7, 12
    s_add_u32 s75, s75, s54
    s_lshl_b32 s54, s76, 8
    s_add_u32 s75, s75, s54
    v_bfe_u32 v251, v1, 5, 1
    v_lshlrev_b32 v251, 10, v251
    v_bfe_u32 v15, v1, 4, 1
    v_lshl_add_u32 v251, v15, 9, v251
    v_and_b32 v15, 15, v1
    v_lshl_add_u32 v251, v15, 4, v251
    v_add_u32 v251, s75, v251
    s_lshr_b32 s75, s74, 2
    s_lshl_b32 s75, s75, 21
    s_and_b32 s100, s74, 3
    s_lshl_b32 s100, s100, 11
    s_add_u32 s75, s75, s100
    s_lshl_b32 s54, s7, 8
    s_add_u32 s75, s75, s54
    s_lshl_b32 s54, s76, 7
    s_add_u32 s75, s75, s54
    v_and_b32 v12, 15, v1
    v_lshlrev_b32 v12, 3, v12
    v_bfe_u32 v15, v1, 5, 1
    v_lshl_add_u32 v12, v15, 2, v12
    v_add_u32 v12, s75, v12
    s_lshr_b32 s75, s74, 2
    s_lshl_b32 s75, s75, 21
    s_and_b32 s100, s74, 3
    s_lshl_b32 s100, s100, 11
    s_add_u32 s75, s75, s100
    v_and_b32 v245, 15, v1
    v_lshlrev_b32 v245, 7, v245
    v_add_u32 v245, 1089536, v245
    v_add_u32 v245, s75, v245
    s_lshl_b32 s73, s4, 2
    s_add_u32 s74, s73, s72
    s_lshr_b32 s62, s74, 2
    s_lshl_b32 s62, s62, 21
    s_and_b32 s100, s74, 3
    s_lshl_b32 s100, s100, 11
    s_add_u32 s62, s62, s100
    s_lshl_b32 s75, s5, 7
    s_add_u32 s62, s62, s75
    s_add_u32 s62, s62, 1089536
    s_lshl_b32 s75, s5, 2
    s_add_u32 s75, s75, s72
    s_lshl_b32 s75, s75, 4
    s_mul_i32 s68, s75, 1152
    s_add_u32 s68, s68, 33554432
    s_add_u32 s75, s75, s4
    s_mul_i32 s60, s75, 1152
    s_add_u32 s60, s60, 33554432
    s_sub_u32 s75, s75, s4
    s_lshl_b32 s63, s75, 7
    s_lshl_b32 s75, s4, 7
    s_add_u32 s63, s63, s75
    s_add_u32 s63, s63, 34865152
    s_mov_b32 s59, 0
    s_mov_b32 s44, 1048576
    s_waitcnt vmcnt(8)
    buffer_store_dwordx4 v[80:83], v251, s[40:43], s59 offen offset:0 sc1
    buffer_store_dwordx4 v[84:87], v251, s[40:43], s59 offen offset:2048 sc1
    v_lshlrev_b32 v16, 16, v80
    v_and_b32 v17, 0xffff0000, v80
    v_lshlrev_b32 v18, 16, v81
    v_and_b32 v19, 0xffff0000, v81
    v_lshlrev_b32 v20, 16, v82
    v_and_b32 v21, 0xffff0000, v82
    v_lshlrev_b32 v22, 16, v83
    v_and_b32 v23, 0xffff0000, v83
    v_lshlrev_b32 v24, 16, v84
    v_and_b32 v25, 0xffff0000, v84
    v_lshlrev_b32 v26, 16, v85
    v_and_b32 v27, 0xffff0000, v85
    v_lshlrev_b32 v28, 16, v86
    v_and_b32 v29, 0xffff0000, v86
    v_lshlrev_b32 v30, 16, v87
    v_and_b32 v31, 0xffff0000, v87
    v_pk_add_f32 v[116:117], v[16:17], v[18:19]
    v_pk_add_f32 v[118:119], v[20:21], v[22:23]
    v_pk_add_f32 v[120:121], v[24:25], v[26:27]
    v_pk_add_f32 v[122:123], v[28:29], v[30:31]
    v_pk_mul_f32 v[124:125], v[16:17], v[16:17]
    v_pk_mul_f32 v[126:127], v[18:19], v[18:19]
    v_pk_add_f32 v[116:117], v[116:117], v[118:119]
    v_pk_add_f32 v[120:121], v[120:121], v[122:123]
    v_pk_fma_f32 v[124:125], v[20:21], v[20:21], v[124:125]
    v_pk_fma_f32 v[126:127], v[22:23], v[22:23], v[126:127]
    v_pk_fma_f32 v[124:125], v[24:25], v[24:25], v[124:125]
    v_pk_fma_f32 v[126:127], v[26:27], v[26:27], v[126:127]
    v_pk_fma_f32 v[124:125], v[28:29], v[28:29], v[124:125]
    v_pk_fma_f32 v[126:127], v[30:31], v[30:31], v[126:127]
    v_pk_add_f32 v[116:117], v[116:117], v[120:121]
    v_pk_add_f32 v[124:125], v[124:125], v[126:127]
    v_add_f32 v116, v116, v117
    v_add_f32 v124, v124, v125
    s_nop 1
    v_permlane32_swap_b32 v116, v124
    v_add_f32 v116, v116, v124
    v_mov_b32 v124, v116
    s_nop 1
    v_permlane16_swap_b32 v116, v124
    v_add_f32 v116, v116, v124
    s_mov_b32 s100, 0xffff
    s_mov_b32 s101, 0xffff
    s_mov_b64 exec, s[100:101]
    buffer_store_dword v116, v12, s[40:43], s44 offen sc1
    s_mov_b64 exec, -1
    s_lshr_b32 s57, s74, 2
    s_lshl_b32 s57, s57, 21
    s_and_b32 s100, s74, 3
    s_lshl_b32 s100, s100, 15
    s_add_u32 s57, s57, s100
    v_lshlrev_b32 v2, 4, v1
    v_bfe_u32 v3, v1, 5, 1
    v_lshlrev_b32 v3, 8, v3
    v_bfe_u32 v15, v1, 2, 2
    v_lshl_add_u32 v3, v15, 6, v3
    v_bfe_u32 v15, v1, 4, 1
    v_lshl_add_u32 v3, v15, 5, v3
    v_and_b32 v15, 3, v1
    v_lshl_add_u32 v3, v15, 3, v3
    v_bfe_u32 v4, v1, 5, 1
    v_lshlrev_b32 v4, 8, v4
    v_bfe_u32 v15, v1, 2, 2
    v_lshl_add_u32 v4, v15, 6, v4
    v_bfe_u32 v15, v1, 4, 1
    v_lshl_add_u32 v4, v15, 5, v4
    v_and_b32 v15, 3, v1
    v_lshl_add_u32 v4, v15, 3, v4
    v_add_u32 v4, 1024, v4
    v_bfe_u32 v5, v1, 5, 1
    v_lshlrev_b32 v5, 8, v5
    v_bfe_u32 v15, v1, 2, 2
    v_lshl_add_u32 v5, v15, 6, v5
    v_bfe_u32 v15, v1, 4, 1
    v_lshl_add_u32 v5, v15, 5, v5
    v_and_b32 v15, 3, v1
    v_lshl_add_u32 v5, v15, 3, v5
    v_add_u32 v5, 512, v5
    v_bfe_u32 v6, v1, 5, 1
    v_lshlrev_b32 v6, 8, v6
    v_bfe_u32 v15, v1, 2, 2
    v_lshl_add_u32 v6, v15, 6, v6
    v_bfe_u32 v15, v1, 4, 1
    v_lshl_add_u32 v6, v15, 5, v6
    v_and_b32 v15, 3, v1
    v_lshl_add_u32 v6, v15, 3, v6
    v_add_u32 v6, 1536, v6
    v_bfe_u32 v7, v1, 5, 1
    v_lshlrev_b32 v7, 10, v7
    v_bfe_u32 v15, v1, 4, 1
    v_lshl_add_u32 v7, v15, 9, v7
    v_and_b32 v15, 15, v1
    v_lshl_add_u32 v7, v15, 4, v7
    v_add_u32 v7, 256, v7
    s_and_b32 s75, s72, 1
    s_lshl_b32 s75, s75, 5
    s_lshr_b32 s76, s72, 1
    s_lshl_b32 s76, s76, 12
    s_add_u32 s75, s75, s76
    v_bfe_u32 v8, v1, 5, 1
    v_lshlrev_b32 v8, 9, v8
    v_bfe_u32 v15, v1, 4, 1
    v_lshl_add_u32 v8, v15, 8, v8
    v_bfe_u32 v15, v1, 2, 2
    v_lshl_add_u32 v8, v15, 6, v8
    v_and_b32 v15, 3, v1
    v_lshl_add_u32 v8, v15, 3, v8
    v_add_u32 v8, 4096, v8
    v_add_u32 v8, s75, v8
    v_add_u32 v9, 61440, v8
    s_sub_u32 s75, s73, 1
    s_cmp_eq_u32 s4, 0
    s_cselect_b32 s75, 0, s75
    s_lshr_b32 s77, s75, 2
    s_lshl_b32 s77, s77, 21
    s_and_b32 s100, s75, 3
    s_lshl_b32 s100, s100, 15
    s_add_u32 s77, s77, s100
    s_lshr_b32 s76, s74, 2
    s_lshl_b32 s76, s76, 21
    s_and_b32 s100, s74, 3
    s_lshl_b32 s100, s100, 11
    s_add_u32 s76, s76, s100
    v_and_b32 v244, 15, v1
    v_lshlrev_b32 v244, 7, v244
    v_add_u32 v244, 1081344, v244
    v_add_u32 v244, s76, v244
    v_bfe_u32 v255, v1, 4, 1
    v_lshlrev_b32 v255, 1, v255
    v_bfe_u32 v15, v1, 3, 1
    v_lshl_add_u32 v255, v15, 0, v255
    v_bfe_u32 v247, v1, 5, 1
    v_lshlrev_b32 v247, 11, v247
    v_bfe_u32 v15, v1, 4, 1
    v_lshl_add_u32 v247, v15, 9, v247
    v_bfe_u32 v15, v1, 2, 2
    v_lshl_add_u32 v247, v15, 7, v247
    v_and_b32 v15, 3, v1
    v_lshl_add_u32 v247, v15, 3, v247
    v_add_u32 v247, 98304, v247
    v_xor_b32 v15, 0, v255
    v_lshl_add_u32 v247, v15, 5, v247
    v_bfe_u32 v248, v1, 5, 1
    v_lshlrev_b32 v248, 11, v248
    v_bfe_u32 v15, v1, 4, 1
    v_lshl_add_u32 v248, v15, 9, v248
    v_bfe_u32 v15, v1, 2, 2
    v_lshl_add_u32 v248, v15, 7, v248
    v_and_b32 v15, 3, v1
    v_lshl_add_u32 v248, v15, 3, v248
    v_add_u32 v248, 98304, v248
    v_xor_b32 v15, 1, v255
    v_lshl_add_u32 v248, v15, 5, v248
    v_bfe_u32 v249, v1, 5, 1
    v_lshlrev_b32 v249, 11, v249
    v_bfe_u32 v15, v1, 4, 1
    v_lshl_add_u32 v249, v15, 9, v249
    v_bfe_u32 v15, v1, 2, 2
    v_lshl_add_u32 v249, v15, 7, v249
    v_and_b32 v15, 3, v1
    v_lshl_add_u32 v249, v15, 3, v249
    v_add_u32 v249, 98304, v249
    v_xor_b32 v15, 2, v255
    v_lshl_add_u32 v249, v15, 5, v249
    v_bfe_u32 v250, v1, 5, 1
    v_lshlrev_b32 v250, 11, v250
    v_bfe_u32 v15, v1, 4, 1
    v_lshl_add_u32 v250, v15, 9, v250
    v_bfe_u32 v15, v1, 2, 2
    v_lshl_add_u32 v250, v15, 7, v250
    v_and_b32 v15, 3, v1
    v_lshl_add_u32 v250, v15, 3, v250
    v_add_u32 v250, 98304, v250
    v_xor_b32 v15, 3, v255
    v_lshl_add_u32 v250, v15, 5, v250
    s_lshr_b32 s75, s74, 2
    s_lshl_b32 s75, s75, 21
    s_and_b32 s100, s74, 3
    s_lshl_b32 s100, s100, 15
    s_add_u32 s75, s75, s100
    s_lshl_b32 s76, s5, 10
    s_add_u32 s75, s75, s76
    v_bfe_u32 v252, v1, 4, 1
    v_lshlrev_b32 v252, 14, v252
    v_bfe_u32 v15, v1, 5, 1
    v_lshl_add_u32 v252, v15, 8, v252
    v_and_b32 v15, 15, v1
    v_lshl_add_u32 v252, v15, 4, v252
    v_add_u32 v252, s75, v252
    v_bfe_u32 v253, v1, 4, 1
    v_lshlrev_b32 v253, 14, v253
    v_bfe_u32 v15, v1, 5, 1
    v_lshl_add_u32 v253, v15, 9, v253
    v_and_b32 v15, 15, v1
    v_lshl_add_u32 v253, v15, 4, v253
    v_add_u32 v253, s75, v253
    s_lshl_b32 s75, s72, 9
    v_and_b32 v13, 31, v1
    v_lshlrev_b32 v13, 4, v13
    v_add_u32 v13, 160768, v13
    v_add_u32 v13, s75, v13
    v_bfe_u32 v14, v1, 5, 1
    v_lshlrev_b32 v14, 4, v14
    v_add_u32 v14, 159744, v14
    s_mov_b32 s80, s5
    s_lshl_b32 s81, s7, 1
    s_and_b32 s75, s72, 1
    s_add_u32 s81, s81, s75
    s_add_u32 s82, s4, 1
    s_and_b32 s82, s82, 15
    s_mov_b32 s70, 0x0000ffff
    s_mov_b32 s71, 0xffff0000
    s_mov_b32 s58, 524288
    s_add_u32 s59, s59, 131072
    s_add_u32 s44, s44, 8192
    s_waitcnt vmcnt(3)
    v_lshl_or_b32 v40, v53, 16, v52
    v_lshl_or_b32 v41, v55, 16, v54
    v_lshl_or_b32 v42, v57, 16, v56
    v_lshl_or_b32 v43, v59, 16, v58
    v_bfe_u32 v15, v1, 2, 1
    v_cmp_eq_u32 vcc, 0, v15
    s_nop 1
    v_cndmask_b32 v32, 0, v40, vcc
    v_cndmask_b32 v33, 0, v41, vcc
    v_cndmask_b32 v34, 0, v42, vcc
    v_cndmask_b32 v35, 0, v43, vcc
    v_cndmask_b32 v36, v40, 0, vcc
    v_cndmask_b32 v37, v41, 0, vcc
    v_cndmask_b32 v38, v42, 0, vcc
    v_cndmask_b32 v39, v43, 0, vcc
    s_mov_b32 s56, 4000000
L_lw18:
    ds_read_b32 v15, v10 offset:76
    s_waitcnt lgkmcnt(0)
    v_readfirstlane_b32 s76, v15
    s_nop 0
    s_cmp_ge_u32 s76, 1
    s_cbranch_scc1 L_lwd18
    s_sub_u32 s56, s56, 1
    s_cbranch_scc0 L_lw18
L_lwd18:
    s_mov_b32 s64, s76
    s_add_u32 s65, s64, 0
    v_mov_b32 v15, s65
    v_lshlrev_b32 v255, 2, v1
    s_waitcnt vmcnt(0)
    s_mov_b32 exec_hi, 0
    buffer_store_dword v15, v255, s[40:43], s61 offen sc1
    s_mov_b32 exec_hi, -1
    v_and_b32 v255, 15, v1
    v_lshlrev_b32 v255, 4, v255
    buffer_load_dword v246, v255, s[36:39], 0 offen sc1
    s_mov_b32 s53, 0
    s_mov_b32 s55, 0
L_A_start:
    s_add_u32 s65, s64, s53
    s_mov_b32 s56, 200000
    s_lshl_b64 exec, 1, s80
    s_mov_b32 s76, 0
L_poll_XA:
    buffer_load_dword v15, v244, s[40:43], 0 offen sc1
    s_waitcnt vmcnt(0)
    v_subrev_u32 v15, s65, v15
    v_cmp_le_u32 vcc, 8, v15
    s_nop 1
    s_cbranch_vccnz L_pollmore_XA
    s_cmp_lg_u32 s76, 0
    s_cbranch_scc1 L_polldone_XA
    s_mov_b32 s76, 1
    s_mov_b64 exec, 0xffff
    s_branch L_poll_XA
L_pollmore_XA:
    s_mov_b64 exec, vcc
    s_sub_u32 s56, s56, 1
    s_cbranch_scc0 L_poll_XA
L_polldone_XA:
    s_mov_b64 exec, -1
    s_add_u32 s53, s53, 1
    s_add_u32 s55, s55, 4
    s_mov_b64 exec, 1
    ds_add_u32 v10, v11 offset:48
    s_mov_b64 exec, -1
    s_mov_b32 s54, s57
    buffer_load_dwordx4 v[116:119], v2, s[40:43], s54 offen offset:0
    buffer_load_dwordx4 v[120:123], v2, s[40:43], s54 offen offset:1024
    buffer_load_dwordx4 v[124:127], v2, s[40:43], s54 offen offset:2048
    buffer_load_dwordx4 v[128:131], v2, s[40:43], s54 offen offset:3072
    s_add_u32 s54, s54, 4096
    buffer_load_dwordx4 v[132:135], v2, s[40:43], s54 offen offset:0
    buffer_load_dwordx4 v[136:139], v2, s[40:43], s54 offen offset:1024
    buffer_load_dwordx4 v[140:143], v2, s[40:43], s54 offen offset:2048
    buffer_load_dwordx4 v[144:147], v2, s[40:43], s54 offen offset:3072
    v_and_b32 v255, 7, v1
    v_lshl_add_u32 v255, v255, 2, v10
    ds_read_b32 v255, v255
    s_add_u32 s54, s54, 4096
    buffer_load_dwordx4 v[148:151], v2, s[40:43], s54 offen offset:0
    buffer_load_dwordx4 v[152:155], v2, s[40:43], s54 offen offset:1024
    s_waitcnt lgkmcnt(0)
    v_cmp_gt_u32 vcc, s55, v255
    s_nop 1
    s_cmp_eq_u64 vcc, 0
    s_cselect_b32 s67, 1, 0
    s_cmp_lg_u32 s67, 0
    s_cbranch_scc1 L_cc19
    s_mov_b32 s56, 4000000
L_lw20:
    ds_read_b32 v255, v10 offset:0
    s_waitcnt lgkmcnt(0)
    v_readfirstlane_b32 s76, v255
    s_nop 0
    s_cmp_ge_u32 s76, s55
    s_cbranch_scc1 L_lwd20
    s_sub_u32 s56, s56, 1
    s_cbranch_scc0 L_lw20
L_lwd20:
L_cc19:
    ds_read_b64_tr_b16 v[40:41], v3 offset:4096
    ds_read_b64_tr_b16 v[42:43], v4 offset:4096
    ds_read_b64_tr_b16 v[44:45], v3 offset:8192
    ds_read_b64_tr_b16 v[46:47], v4 offset:8192
    ds_read_b64_tr_b16 v[48:49], v5 offset:4096
    ds_read_b64_tr_b16 v[50:51], v6 offset:4096
    ds_read_b64_tr_b16 v[52:53], v5 offset:8192
    ds_read_b64_tr_b16 v[54:55], v6 offset:8192
    s_waitcnt vmcnt(9) lgkmcnt(6)
    v_mfma_f32_32x32x16_bf16 v[80:95], v[40:43], v[116:119], 0
    ds_read_b64_tr_b16 v[56:57], v3 offset:6144
    ds_read_b64_tr_b16 v[58:59], v4 offset:6144
    buffer_load_dwordx4 v[156:159], v2, s[40:43], s54 offen offset:2048
    s_waitcnt lgkmcnt(6)
    v_mfma_f32_32x32x16_bf16 v[96:111], v[44:47], v[116:119], 0
    ds_read_b64_tr_b16 v[60:61], v3 offset:10240
    ds_read_b64_tr_b16 v[62:63], v4 offset:10240
    buffer_load_dwordx4 v[160:163], v2, s[40:43], s54 offen offset:3072
    s_waitcnt vmcnt(10) lgkmcnt(6)
    v_mfma_f32_32x32x16_bf16 v[80:95], v[48:51], v[120:123], v[80:95]
    ds_read_b64_tr_b16 v[40:41], v5 offset:6144
    ds_read_b64_tr_b16 v[42:43], v6 offset:6144
    s_add_u32 s54, s54, 4096
    buffer_load_dwordx4 v[164:167], v2, s[40:43], s54 offen offset:0
    s_waitcnt lgkmcnt(6)
    v_mfma_f32_32x32x16_bf16 v[96:111], v[52:55], v[120:123], v[96:111]
    ds_read_b64_tr_b16 v[44:45], v5 offset:10240
    ds_read_b64_tr_b16 v[46:47], v6 offset:10240
    buffer_load_dwordx4 v[168:171], v2, s[40:43], s54 offen offset:1024
    s_cmp_lg_u32 s67, 0
    s_cbranch_scc1 L_cc21
    s_mov_b32 s56, 4000000
L_lw22:
    ds_read_b32 v255, v10 offset:4
    s_waitcnt lgkmcnt(0)
    v_readfirstlane_b32 s76, v255
    s_nop 0
    s_cmp_ge_u32 s76, s55
    s_cbranch_scc1 L_lwd22
    s_sub_u32 s56, s56, 1
    s_cbranch_scc0 L_lw22
L_lwd22:
L_cc21:
    s_waitcnt vmcnt(11) lgkmcnt(6)
    v_mfma_f32_32x32x16_bf16 v[80:95], v[56:59], v[124:127], v[80:95]
    ds_read_b64_tr_b16 v[48:49], v3 offset:16384
    ds_read_b64_tr_b16 v[50:51], v4 offset:16384
    buffer_load_dwordx4 v[172:175], v2, s[40:43], s54 offen offset:2048
    s_waitcnt lgkmcnt(6)
    v_mfma_f32_32x32x16_bf16 v[96:111], v[60:63], v[124:127], v[96:111]
    ds_read_b64_tr_b16 v[52:53], v3 offset:20480
    ds_read_b64_tr_b16 v[54:55], v4 offset:20480
    buffer_load_dwordx4 v[176:179], v2, s[40:43], s54 offen offset:3072
    s_waitcnt vmcnt(12) lgkmcnt(6)
    v_mfma_f32_32x32x16_bf16 v[80:95], v[40:43], v[128:131], v[80:95]
    ds_read_b64_tr_b16 v[56:57], v5 offset:16384
    ds_read_b64_tr_b16 v[58:59], v6 offset:16384
    s_add_u32 s54, s54, 4096
    buffer_load_dwordx4 v[180:183], v2, s[40:43], s54 offen offset:0
    s_waitcnt lgkmcnt(6)
    v_mfma_f32_32x32x16_bf16 v[96:111], v[44:47], v[128:131], v[96:111]
    ds_read_b64_tr_b16 v[60:61], v5 offset:20480
    ds_read_b64_tr_b16 v[62:63], v6 offset:20480
    buffer_load_dwordx4 v[184:187], v2, s[40:43], s54 offen offset:1024
    s_waitcnt vmcnt(13) lgkmcnt(6)
    v_mfma_f32_32x32x16_bf16 v[80:95], v[48:51], v[132:135], v[80:95]
    ds_read_b64_tr_b16 v[40:41], v3 offset:18432
    ds_read_b64_tr_b16 v[42:43], v4 offset:18432
    buffer_load_dwordx4 v[188:191], v2, s[40:43], s54 offen offset:2048
    s_waitcnt lgkmcnt(6)
    v_mfma_f32_32x32x16_bf16 v[96:111], v[52:55], v[132:135], v[96:111]
    ds_read_b64_tr_b16 v[44:45], v3 offset:22528
    ds_read_b64_tr_b16 v[46:47], v4 offset:22528
    buffer_load_dwordx4 v[192:195], v2, s[40:43], s54 offen offset:3072
    s_waitcnt vmcnt(14) lgkmcnt(6)
    v_mfma_f32_32x32x16_bf16 v[80:95], v[56:59], v[136:139], v[80:95]
    ds_read_b64_tr_b16 v[48:49], v5 offset:18432
    ds_read_b64_tr_b16 v[50:51], v6 offset:18432
    s_add_u32 s54, s54, 4096
    buffer_load_dwordx4 v[196:199], v2, s[40:43], s54 offen offset:0
    s_waitcnt lgkmcnt(6)
    v_mfma_f32_32x32x16_bf16 v[96:111], v[60:63], v[136:139], v[96:111]
    ds_read_b64_tr_b16 v[52:53], v5 offset:22528
    ds_read_b64_tr_b16 v[54:55], v6 offset:22528
    buffer_load_dwordx4 v[200:203], v2, s[40:43], s54 offen offset:1024
    s_cmp_lg_u32 s67, 0
    s_cbranch_scc1 L_cc23
    s_mov_b32 s56, 4000000
L_lw24:
    ds_read_b32 v255, v10 offset:8
    s_waitcnt lgkmcnt(0)
    v_readfirstlane_b32 s76, v255
    s_nop 0
    s_cmp_ge_u32 s76, s55
    s_cbranch_scc1 L_lwd24
    s_sub_u32 s56, s56, 1
    s_cbranch_scc0 L_lw24
L_lwd24:
L_cc23:
    s_waitcnt vmcnt(15) lgkmcnt(6)
    v_mfma_f32_32x32x16_bf16 v[80:95], v[40:43], v[140:143], v[80:95]
    ds_read_b64_tr_b16 v[56:57], v3 offset:28672
    ds_read_b64_tr_b16 v[58:59], v4 offset:28672
    buffer_load_dwordx4 v[204:207], v2, s[40:43], s54 offen offset:2048
    s_waitcnt lgkmcnt(6)
    v_mfma_f32_32x32x16_bf16 v[96:111], v[44:47], v[140:143], v[96:111]
    ds_read_b64_tr_b16 v[60:61], v3 offset:32768
    ds_read_b64_tr_b16 v[62:63], v4 offset:32768
    buffer_load_dwordx4 v[208:211], v2, s[40:43], s54 offen offset:3072
    s_waitcnt vmcnt(16) lgkmcnt(6)
    v_mfma_f32_32x32x16_bf16 v[80:95], v[48:51], v[144:147], v[80:95]
    ds_read_b64_tr_b16 v[40:41], v5 offset:28672
    ds_read_b64_tr_b16 v[42:43], v6 offset:28672
    s_add_u32 s54, s54, 4096
    buffer_load_dwordx4 v[212:215], v2, s[40:43], s54 offen offset:0
    s_waitcnt lgkmcnt(6)
    v_mfma_f32_32x32x16_bf16 v[96:111], v[52:55], v[144:147], v[96:111]
    ds_read_b64_tr_b16 v[44:45], v5 offset:32768
    ds_read_b64_tr_b16 v[46:47], v6 offset:32768
    buffer_load_dwordx4 v[216:219], v2, s[40:43], s54 offen offset:1024
    s_waitcnt vmcnt(17) lgkmcnt(6)
    v_mfma_f32_32x32x16_bf16 v[80:95], v[56:59], v[148:151], v[80:95]
    ds_read_b64_tr_b16 v[48:49], v3 offset:30720
    ds_read_b64_tr_b16 v[50:51], v4 offset:30720
    buffer_load_dwordx4 v[220:223], v2, s[40:43], s54 offen offset:2048
    s_waitcnt lgkmcnt(6)
    v_mfma_f32_32x32x16_bf16 v[96:111], v[60:63], v[148:151], v[96:111]
    ds_read_b64_tr_b16 v[52:53], v3 offset:34816
    ds_read_b64_tr_b16 v[54:55], v4 offset:34816
    buffer_load_dwordx4 v[224:227], v2, s[40:43], s54 offen offset:3072
    s_waitcnt vmcnt(18) lgkmcnt(6)
    v_mfma_f32_32x32x16_bf16 v[80:95], v[40:43], v[152:155], v[80:95]
    ds_read_b64_tr_b16 v[56:57], v5 offset:30720
    ds_read_b64_tr_b16 v[58:59], v6 offset:30720
    s_add_u32 s54, s54, 4096
    buffer_load_dwordx4 v[228:231], v2, s[40:43], s54 offen offset:0
    s_waitcnt lgkmcnt(6)
    v_mfma_f32_32x32x16_bf16 v[96:111], v[44:47], v[152:155], v[96:111]
    ds_read_b64_tr_b16 v[60:61], v5 offset:34816
    ds_read_b64_tr_b16 v[62:63], v6 offset:34816
    buffer_load_dwordx4 v[232:235], v2, s[40:43], s54 offen offset:1024
    s_cmp_lg_u32 s67, 0
    s_cbranch_scc1 L_cc25
    s_mov_b32 s56, 4000000
L_lw26:
    ds_read_b32 v255, v10 offset:12
    s_waitcnt lgkmcnt(0)
    v_readfirstlane_b32 s76, v255
    s_nop 0
    s_cmp_ge_u32 s76, s55
    s_cbranch_scc1 L_lwd26
    s_sub_u32 s56, s56, 1
    s_cbranch_scc0 L_lw26
L_lwd26:
L_cc25:
    s_waitcnt vmcnt(19) lgkmcnt(6)
    v_mfma_f32_32x32x16_bf16 v[80:95], v[48:51], v[156:159], v[80:95]
    ds_read_b64_tr_b16 v[40:41], v3 offset:40960
    ds_read_b64_tr_b16 v[42:43], v4 offset:40960
    buffer_load_dwordx4 v[236:239], v2, s[40:43], s54 offen offset:2048
    s_waitcnt lgkmcnt(6)
    v_mfma_f32_32x32x16_bf16 v[96:111], v[52:55], v[156:159], v[96:111]
    ds_read_b64_tr_b16 v[44:45], v3 offset:45056
    ds_read_b64_tr_b16 v[46:47], v4 offset:45056
    buffer_load_dwordx4 v[240:243], v2, s[40:43], s54 offen offset:3072
    s_waitcnt vmcnt(20) lgkmcnt(6)
    v_mfma_f32_32x32x16_bf16 v[80:95], v[56:59], v[160:163], v[80:95]
    ds_read_b64_tr_b16 v[48:49], v5 offset:40960
    ds_read_b64_tr_b16 v[50:51], v6 offset:40960
    s_waitcnt lgkmcnt(6)
    v_mfma_f32_32x32x16_bf16 v[96:111], v[60:63], v[160:163], v[96:111]
    ds_read_b64_tr_b16 v[52:53], v5 offset:45056
    ds_read_b64_tr_b16 v[54:55], v6 offset:45056
    s_waitcnt vmcnt(19) lgkmcnt(6)
    v_mfma_f32_32x32x16_bf16 v[80:95], v[40:43], v[164:167], v[80:95]
    ds_read_b64_tr_b16 v[56:57], v3 offset:43008
    ds_read_b64_tr_b16 v[58:59], v4 offset:43008
    s_waitcnt lgkmcnt(6)
    v_mfma_f32_32x32x16_bf16 v[96:111], v[44:47], v[164:167], v[96:111]
    ds_read_b64_tr_b16 v[60:61], v3 offset:47104
    ds_read_b64_tr_b16 v[62:63], v4 offset:47104
    s_mov_b64 exec, 1
    ds_add_u32 v10, v11 offset:64
    s_mov_b64 exec, -1
    s_waitcnt vmcnt(18) lgkmcnt(7)
    v_mfma_f32_32x32x16_bf16 v[80:95], v[48:51], v[168:171], v[80:95]
    ds_read_b64_tr_b16 v[40:41], v5 offset:43008
    ds_read_b64_tr_b16 v[42:43], v6 offset:43008
    s_waitcnt lgkmcnt(7)
    v_mfma_f32_32x32x16_bf16 v[96:111], v[52:55], v[168:171], v[96:111]
    ds_read_b64_tr_b16 v[44:45], v5 offset:47104
    ds_read_b64_tr_b16 v[46:47], v6 offset:47104
    s_cmp_lg_u32 s67, 0
    s_cbranch_scc1 L_cc27
    s_mov_b32 s56, 4000000
L_lw28:
    ds_read_b32 v255, v10 offset:16
    s_waitcnt lgkmcnt(0)
    v_readfirstlane_b32 s76, v255
    s_nop 0
    s_cmp_ge_u32 s76, s55
    s_cbranch_scc1 L_lwd28
    s_sub_u32 s56, s56, 1
    s_cbranch_scc0 L_lw28
L_lwd28:
L_cc27:
    s_waitcnt vmcnt(17) lgkmcnt(7)
    v_mfma_f32_32x32x16_bf16 v[80:95], v[56:59], v[172:175], v[80:95]
    ds_read_b64_tr_b16 v[48:49], v3 offset:53248
    ds_read_b64_tr_b16 v[50:51], v4 offset:53248
    s_waitcnt lgkmcnt(7)
    v_mfma_f32_32x32x16_bf16 v[96:111], v[60:63], v[172:175], v[96:111]
    ds_read_b64_tr_b16 v[52:53], v3 offset:57344
    ds_read_b64_tr_b16 v[54:55], v4 offset:57344
    s_waitcnt vmcnt(16) lgkmcnt(6)
    v_mfma_f32_32x32x16_bf16 v[80:95], v[40:43], v[176:179], v[80:95]
    ds_read_b64_tr_b16 v[56:57], v5 offset:53248
    ds_read_b64_tr_b16 v[58:59], v6 offset:53248
    s_waitcnt lgkmcnt(6)
    v_mfma_f32_32x32x16_bf16 v[96:111], v[44:47], v[176:179], v[96:111]
    ds_read_b64_tr_b16 v[60:61], v5 offset:57344
    ds_read_b64_tr_b16 v[62:63], v6 offset:57344
    s_waitcnt vmcnt(15) lgkmcnt(6)
    v_mfma_f32_32x32x16_bf16 v[80:95], v[48:51], v[180:183], v[80:95]
    ds_read_b64_tr_b16 v[40:41], v3 offset:55296
    ds_read_b64_tr_b16 v[42:43], v4 offset:55296
    s_waitcnt lgkmcnt(6)
    v_mfma_f32_32x32x16_bf16 v[96:111], v[52:55], v[180:183], v[96:111]
    ds_read_b64_tr_b16 v[44:45], v3 offset:59392
    ds_read_b64_tr_b16 v[46:47], v4 offset:59392
    s_waitcnt vmcnt(14) lgkmcnt(6)
    v_mfma_f32_32x32x16_bf16 v[80:95], v[56:59], v[184:187], v[80:95]
    ds_read_b64_tr_b16 v[48:49], v5 offset:55296
    ds_read_b64_tr_b16 v[50:51], v6 offset:55296
    s_waitcnt lgkmcnt(6)
    v_mfma_f32_32x32x16_bf16 v[96:111], v[60:63], v[184:187], v[96:111]
    ds_read_b64_tr_b16 v[52:53], v5 offset:59392
    ds_read_b64_tr_b16 v[54:55], v6 offset:59392
    s_cmp_lg_u32 s67, 0
    s_cbranch_scc1 L_cc29
    s_mov_b32 s56, 4000000
L_lw30:
    ds_read_b32 v255, v10 offset:20
    s_waitcnt lgkmcnt(0)
    v_readfirstlane_b32 s76, v255
    s_nop 0
    s_cmp_ge_u32 s76, s55
    s_cbranch_scc1 L_lwd30
    s_sub_u32 s56, s56, 1
    s_cbranch_scc0 L_lw30
L_lwd30:
L_cc29:
    v_add_u32 v3, 61440, v3
    v_add_u32 v4, 61440, v4
    v_add_u32 v5, 61440, v5
    v_add_u32 v6, 61440, v6
    s_waitcnt vmcnt(13) lgkmcnt(6)
    v_mfma_f32_32x32x16_bf16 v[80:95], v[40:43], v[188:191], v[80:95]
    ds_read_b64_tr_b16 v[56:57], v3 offset:4096
    ds_read_b64_tr_b16 v[58:59], v4 offset:4096
    s_waitcnt lgkmcnt(6)
    v_mfma_f32_32x32x16_bf16 v[96:111], v[44:47], v[188:191], v[96:111]
    ds_read_b64_tr_b16 v[60:61], v3 offset:8192
    ds_read_b64_tr_b16 v[62:63], v4 offset:8192
    s_waitcnt vmcnt(12) lgkmcnt(6)
    v_mfma_f32_32x32x16_bf16 v[80:95], v[48:51], v[192:195], v[80:95]
    ds_read_b64_tr_b16 v[40:41], v5 offset:4096
    ds_read_b64_tr_b16 v[42:43], v6 offset:4096
    s_waitcnt lgkmcnt(6)
    v_mfma_f32_32x32x16_bf16 v[96:111], v[52:55], v[192:195], v[96:111]
    ds_read_b64_tr_b16 v[44:45], v5 offset:8192
    ds_read_b64_tr_b16 v[46:47], v6 offset:8192
    s_waitcnt vmcnt(11) lgkmcnt(6)
    v_mfma_f32_32x32x16_bf16 v[80:95], v[56:59], v[196:199], v[80:95]
    ds_read_b64_tr_b16 v[48:49], v3 offset:6144
    ds_read_b64_tr_b16 v[50:51], v4 offset:6144
    s_waitcnt lgkmcnt(6)
    v_mfma_f32_32x32x16_bf16 v[96:111], v[60:63], v[196:199], v[96:111]
    ds_read_b64_tr_b16 v[52:53], v3 offset:10240
    ds_read_b64_tr_b16 v[54:55], v4 offset:10240
    s_waitcnt vmcnt(10) lgkmcnt(6)
    v_mfma_f32_32x32x16_bf16 v[80:95], v[40:43], v[200:203], v[80:95]
    ds_read_b64_tr_b16 v[56:57], v5 offset:6144
    ds_read_b64_tr_b16 v[58:59], v6 offset:6144
    s_waitcnt lgkmcnt(6)
    v_mfma_f32_32x32x16_bf16 v[96:111], v[44:47], v[200:203], v[96:111]
    ds_read_b64_tr_b16 v[60:61], v5 offset:10240
    ds_read_b64_tr_b16 v[62:63], v6 offset:10240
    s_cmp_lg_u32 s67, 0
    s_cbranch_scc1 L_cc31
    s_mov_b32 s56, 4000000
L_lw32:
    ds_read_b32 v255, v10 offset:24
    s_waitcnt lgkmcnt(0)
    v_readfirstlane_b32 s76, v255
    s_nop 0
    s_cmp_ge_u32 s76, s55
    s_cbranch_scc1 L_lwd32
    s_sub_u32 s56, s56, 1
    s_cbranch_scc0 L_lw32
L_lwd32:
L_cc31:
    s_waitcnt vmcnt(9) lgkmcnt(6)
    v_mfma_f32_32x32x16_bf16 v[80:95], v[48:51], v[204:207], v[80:95]
    ds_read_b64_tr_b16 v[40:41], v3 offset:16384
    ds_read_b64_tr_b16 v[42:43], v4 offset:16384
    s_waitcnt lgkmcnt(6)
    v_mfma_f32_32x32x16_bf16 v[96:111], v[52:55], v[204:207], v[96:111]
    ds_read_b64_tr_b16 v[44:45], v3 offset:20480
    ds_read_b64_tr_b16 v[46:47], v4 offset:20480
    s_waitcnt vmcnt(8) lgkmcnt(6)
    v_mfma_f32_32x32x16_bf16 v[80:95], v[56:59], v[208:211], v[80:95]
    ds_read_b64_tr_b16 v[48:49], v5 offset:16384
    ds_read_b64_tr_b16 v[50:51], v6 offset:16384
    s_waitcnt lgkmcnt(6)
    v_mfma_f32_32x32x16_bf16 v[96:111], v[60:63], v[208:211], v[96:111]
    ds_read_b64_tr_b16 v[52:53], v5 offset:20480
    ds_read_b64_tr_b16 v[54:55], v6 offset:20480
    s_waitcnt vmcnt(7) lgkmcnt(6)
    v_mfma_f32_32x32x16_bf16 v[80:95], v[40:43], v[212:215], v[80:95]
    ds_read_b64_tr_b16 v[56:57], v3 offset:18432
    ds_read_b64_tr_b16 v[58:59], v4 offset:18432
    s_waitcnt lgkmcnt(6)
    v_mfma_f32_32x32x16_bf16 v[96:111], v[44:47], v[212:215], v[96:111]
    ds_read_b64_tr_b16 v[60:61], v3 offset:22528
    ds_read_b64_tr_b16 v[62:63], v4 offset:22528
    s_waitcnt vmcnt(6) lgkmcnt(6)
    v_mfma_f32_32x32x16_bf16 v[80:95], v[48:51], v[216:219], v[80:95]
    ds_read_b64_tr_b16 v[40:41], v5 offset:18432
    ds_read_b64_tr_b16 v[42:43], v6 offset:18432
    s_waitcnt lgkmcnt(6)
    v_mfma_f32_32x32x16_bf16 v[96:111], v[52:55], v[216:219], v[96:111]
    ds_read_b64_tr_b16 v[44:45], v5 offset:22528
    ds_read_b64_tr_b16 v[46:47], v6 offset:22528
    s_cmp_lg_u32 s67, 0
    s_cbranch_scc1 L_cc33
    s_mov_b32 s56, 4000000
L_lw34:
    ds_read_b32 v255, v10 offset:28
    s_waitcnt lgkmcnt(0)
    v_readfirstlane_b32 s76, v255
    s_nop 0
    s_cmp_ge_u32 s76, s55
    s_cbranch_scc1 L_lwd34
    s_sub_u32 s56, s56, 1
    s_cbranch_scc0 L_lw34
L_lwd34:
L_cc33:
    s_waitcnt vmcnt(5) lgkmcnt(6)
    v_mfma_f32_32x32x16_bf16 v[80:95], v[56:59], v[220:223], v[80:95]
    ds_read_b64_tr_b16 v[48:49], v3 offset:28672
    ds_read_b64_tr_b16 v[50:51], v4 offset:28672
    s_waitcnt lgkmcnt(6)
    v_mfma_f32_32x32x16_bf16 v[96:111], v[60:63], v[220:223], v[96:111]
    ds_read_b64_tr_b16 v[52:53], v3 offset:32768
    ds_read_b64_tr_b16 v[54:55], v4 offset:32768
    s_waitcnt vmcnt(4) lgkmcnt(6)
    v_mfma_f32_32x32x16_bf16 v[80:95], v[40:43], v[224:227], v[80:95]
    ds_read_b64_tr_b16 v[56:57], v5 offset:28672
    ds_read_b64_tr_b16 v[58:59], v6 offset:28672
    s_waitcnt lgkmcnt(6)
    v_mfma_f32_32x32x16_bf16 v[96:111], v[44:47], v[224:227], v[96:111]
    ds_read_b64_tr_b16 v[60:61], v5 offset:32768
    ds_read_b64_tr_b16 v[62:63], v6 offset:32768
    s_waitcnt vmcnt(3) lgkmcnt(6)
    v_mfma_f32_32x32x16_bf16 v[80:95], v[48:51], v[228:231], v[80:95]
    ds_read_b64_tr_b16 v[40:41], v3 offset:30720
    ds_read_b64_tr_b16 v[42:43], v4 offset:30720
    s_waitcnt lgkmcnt(6)
    v_mfma_f32_32x32x16_bf16 v[96:111], v[52:55], v[228:231], v[96:111]
    ds_read_b64_tr_b16 v[44:45], v3 offset:34816
    ds_read_b64_tr_b16 v[46:47], v4 offset:34816
    s_waitcnt vmcnt(2) lgkmcnt(6)
    v_mfma_f32_32x32x16_bf16 v[80:95], v[56:59], v[232:235], v[80:95]
    ds_read_b64_tr_b16 v[48:49], v5 offset:30720
    ds_read_b64_tr_b16 v[50:51], v6 offset:30720
    s_waitcnt lgkmcnt(6)
    v_mfma_f32_32x32x16_bf16 v[96:111], v[60:63], v[232:235], v[96:111]
    ds_read_b64_tr_b16 v[52:53], v5 offset:34816
    ds_read_b64_tr_b16 v[54:55], v6 offset:34816
    ds_read_b32 v15, v10 offset:32
    ds_read_b128 v[112:115], v13
    ds_read_b128 v[64:67], v14 offset:128
    ds_read_b128 v[68:71], v14 offset:160
    ds_read_b128 v[72:75], v14 offset:192
    ds_read_b128 v[76:79], v14 offset:224
    s_waitcnt vmcnt(1) lgkmcnt(12)
    v_mfma_f32_32x32x16_bf16 v[80:95], v[40:43], v[236:239], v[80:95]
    s_waitcnt lgkmcnt(10)
    v_mfma_f32_32x32x16_bf16 v[96:111], v[44:47], v[236:239], v[96:111]
    s_waitcnt vmcnt(0) lgkmcnt(8)
    v_mfma_f32_32x32x16_bf16 v[80:95], v[48:51], v[240:243], v[80:95]
    s_waitcnt lgkmcnt(6)
    v_mfma_f32_32x32x16_bf16 v[96:111], v[52:55], v[240:243], v[96:111]
    v_subrev_u32 v3, 61440, v3
    v_subrev_u32 v4, 61440, v4
    v_subrev_u32 v5, 61440, v5
    v_subrev_u32 v6, 61440, v6
    s_waitcnt lgkmcnt(0)
    s_mov_b64 exec, 1
    ds_add_u32 v10, v11 offset:36
    s_mov_b64 exec, -1
    v_readfirstlane_b32 s76, v15
    s_nop 0
    s_cmp_ge_u32 s76, s55
    s_cbranch_scc1 L_cf35
    s_mov_b32 s56, 4000000
L_lw36:
    ds_read_b32 v15, v10 offset:32
    s_waitcnt lgkmcnt(0)
    v_readfirstlane_b32 s76, v15
    s_nop 0
    s_cmp_ge_u32 s76, s55
    s_cbranch_scc1 L_lwd36
    s_sub_u32 s56, s56, 1
    s_cbranch_scc0 L_lw36
L_lwd36:
    ds_read_b128 v[112:115], v13
    ds_read_b128 v[64:67], v14 offset:128
    ds_read_b128 v[68:71], v14 offset:160
    ds_read_b128 v[72:75], v14 offset:192
    ds_read_b128 v[76:79], v14 offset:224
    s_waitcnt lgkmcnt(0)
L_cf35:
    s_nop 3
    v_pk_fma_f32 v[80:81], v[64:65], v[114:115], v[80:81] op_sel_hi:[1,0,1]
    v_pk_fma_f32 v[82:83], v[66:67], v[114:115], v[82:83] op_sel_hi:[1,0,1]
    v_pk_fma_f32 v[84:85], v[68:69], v[114:115], v[84:85] op_sel_hi:[1,0,1]
    v_pk_fma_f32 v[86:87], v[70:71], v[114:115], v[86:87] op_sel_hi:[1,0,1]
    v_pk_fma_f32 v[88:89], v[72:73], v[114:115], v[88:89] op_sel_hi:[1,0,1]
    v_pk_fma_f32 v[90:91], v[74:75], v[114:115], v[90:91] op_sel_hi:[1,0,1]
    v_pk_fma_f32 v[92:93], v[76:77], v[114:115], v[92:93] op_sel_hi:[1,0,1]
    v_pk_fma_f32 v[94:95], v[78:79], v[114:115], v[94:95] op_sel_hi:[1,0,1]
    v_cvt_pk_bf16_f32 v40, v80, v81
    v_cvt_pk_bf16_f32 v41, v82, v83
    v_cvt_pk_bf16_f32 v42, v84, v85
    v_cvt_pk_bf16_f32 v43, v86, v87
    v_cvt_pk_bf16_f32 v44, v88, v89
    v_cvt_pk_bf16_f32 v45, v90, v91
    v_cvt_pk_bf16_f32 v46, v92, v93
    v_cvt_pk_bf16_f32 v47, v94, v95
    ds_read_b128 v[80:83], v14 offset:256
    ds_read_b128 v[84:87], v14 offset:288
    ds_read_b128 v[88:91], v14 offset:320
    ds_read_b128 v[92:95], v14 offset:352
    v_mfma_f32_32x32x16_bf16 v[64:79], v[32:35], v[40:43], 0
    v_mfma_f32_32x32x16_bf16 v[64:79], v[36:39], v[44:47], v[64:79]
    s_lshl_b32 s73, s72, 10
    s_waitcnt lgkmcnt(0)
    v_pk_mul_f32 v[80:81], v[80:81], v[112:113] op_sel:[0,1] op_sel_hi:[1,1]
    v_pk_mul_f32 v[82:83], v[82:83], v[112:113] op_sel:[0,1] op_sel_hi:[1,1]
    v_pk_mul_f32 v[84:85], v[84:85], v[112:113] op_sel:[0,1] op_sel_hi:[1,1]
    v_pk_mul_f32 v[86:87], v[86:87], v[112:113] op_sel:[0,1] op_sel_hi:[1,1]
    v_pk_mul_f32 v[88:89], v[88:89], v[112:113] op_sel:[0,1] op_sel_hi:[1,1]
    v_pk_mul_f32 v[90:91], v[90:91], v[112:113] op_sel:[0,1] op_sel_hi:[1,1]
    v_pk_mul_f32 v[92:93], v[92:93], v[112:113] op_sel:[0,1] op_sel_hi:[1,1]
    v_pk_mul_f32 v[94:95], v[94:95], v[112:113] op_sel:[0,1] op_sel_hi:[1,1]
    v_pk_fma_f32 v[96:97], v[96:97], v[112:113], v[80:81] op_sel_hi:[1,0,1]
    v_pk_fma_f32 v[98:99], v[98:99], v[112:113], v[82:83] op_sel_hi:[1,0,1]
    v_pk_fma_f32 v[100:101], v[100:101], v[112:113], v[84:85] op_sel_hi:[1,0,1]
    v_pk_fma_f32 v[102:103], v[102:103], v[112:113], v[86:87] op_sel_hi:[1,0,1]
    v_pk_fma_f32 v[104:105], v[104:105], v[112:113], v[88:89] op_sel_hi:[1,0,1]
    v_pk_fma_f32 v[106:107], v[106:107], v[112:113], v[90:91] op_sel_hi:[1,0,1]
    v_pk_fma_f32 v[108:109], v[108:109], v[112:113], v[92:93] op_sel_hi:[1,0,1]
    v_pk_fma_f32 v[110:111], v[110:111], v[112:113], v[94:95] op_sel_hi:[1,0,1]
    v_cvt_pk_bf16_f32 v48, v96, v97
    v_cvt_pk_bf16_f32 v49, v98, v99
    v_cvt_pk_bf16_f32 v50, v100, v101
    v_cvt_pk_bf16_f32 v51, v102, v103
    v_cvt_pk_bf16_f32 v52, v104, v105
    v_cvt_pk_bf16_f32 v53, v106, v107
    v_cvt_pk_bf16_f32 v54, v108, v109
    v_cvt_pk_bf16_f32 v55, v110, v111
    v_and_b32 v41, 31, v1
    v_lshlrev_b32 v41, 5, v41
    v_bfe_u32 v15, v1, 5, 1
    v_lshl_add_u32 v41, v15, 4, v41
    v_add_u32 v41, 90112, v41
    v_add_u32 v41, s73, v41
    v_and_b32 v42, 31, v1
    v_lshlrev_b32 v42, 5, v42
    v_bfe_u32 v15, v1, 5, 1
    v_mul_u32_u24 v15, 12288, v15
    v_add_u32 v42, v15, v42
    v_add_u32 v42, 65536, v42
    v_add_u32 v42, s73, v42
    v_max3_f32 v56, v64, v65, v66
    v_min3_f32 v58, v64, v65, v66
    v_max3_f32 v56, v56, v67, v68
    v_min3_f32 v58, v58, v67, v68
    v_max3_f32 v56, v56, v69, v70
    v_min3_f32 v58, v58, v69, v70
    v_max3_f32 v56, v56, v71, v72
    v_min3_f32 v58, v58, v71, v72
    v_max3_f32 v56, v56, v73, v74
    v_min3_f32 v58, v58, v73, v74
    v_max3_f32 v56, v56, v75, v76
    v_min3_f32 v58, v58, v75, v76
    v_max3_f32 v56, v56, v77, v78
    v_min3_f32 v58, v58, v77, v78
    v_max_f32 v56, v56, v79
    v_min_f32 v58, v58, v79
    v_mul_f32 v56, v115, v56
    v_mul_f32 v58, v115, v58
    v_pk_fma_f32 v[80:81], v[64:65], v[114:115], v[56:57] op_sel:[0,1,0] op_sel_hi:[1,1,0] neg_lo:[0,0,1] neg_hi:[0,0,1]
    v_pk_fma_f32 v[82:83], v[66:67], v[114:115], v[56:57] op_sel:[0,1,0] op_sel_hi:[1,1,0] neg_lo:[0,0,1] neg_hi:[0,0,1]
    v_pk_fma_f32 v[84:85], v[68:69], v[114:115], v[56:57] op_sel:[0,1,0] op_sel_hi:[1,1,0] neg_lo:[0,0,1] neg_hi:[0,0,1]
    v_pk_fma_f32 v[86:87], v[70:71], v[114:115], v[56:57] op_sel:[0,1,0] op_sel_hi:[1,1,0] neg_lo:[0,0,1] neg_hi:[0,0,1]
    v_pk_fma_f32 v[88:89], v[72:73], v[114:115], v[56:57] op_sel:[0,1,0] op_sel_hi:[1,1,0] neg_lo:[0,0,1] neg_hi:[0,0,1]
    v_pk_fma_f32 v[90:91], v[74:75], v[114:115], v[56:57] op_sel:[0,1,0] op_sel_hi:[1,1,0] neg_lo:[0,0,1] neg_hi:[0,0,1]
    v_pk_fma_f32 v[92:93], v[76:77], v[114:115], v[56:57] op_sel:[0,1,0] op_sel_hi:[1,1,0] neg_lo:[0,0,1] neg_hi:[0,0,1]
    v_pk_fma_f32 v[94:95], v[78:79], v[114:115], v[56:57] op_sel:[0,1,0] op_sel_hi:[1,1,0] neg_lo:[0,0,1] neg_hi:[0,0,1]
    v_pk_fma_f32 v[96:97], v[64:65], v[114:115], v[58:59] op_sel:[0,1,0] op_sel_hi:[1,1,0] neg_lo:[0,1,0] neg_hi:[0,1,0]
    v_pk_fma_f32 v[98:99], v[66:67], v[114:115], v[58:59] op_sel:[0,1,0] op_sel_hi:[1,1,0] neg_lo:[0,1,0] neg_hi:[0,1,0]
    v_pk_fma_f32 v[100:101], v[68:69], v[114:115], v[58:59] op_sel:[0,1,0] op_sel_hi:[1,1,0] neg_lo:[0,1,0] neg_hi:[0,1,0]
    v_pk_fma_f32 v[102:103], v[70:71], v[114:115], v[58:59] op_sel:[0,1,0] op_sel_hi:[1,1,0] neg_lo:[0,1,0] neg_hi:[0,1,0]
    v_pk_fma_f32 v[104:105], v[72:73], v[114:115], v[58:59] op_sel:[0,1,0] op_sel_hi:[1,1,0] neg_lo:[0,1,0] neg_hi:[0,1,0]
    v_pk_fma_f32 v[106:107], v[74:75], v[114:115], v[58:59] op_sel:[0,1,0] op_sel_hi:[1,1,0] neg_lo:[0,1,0] neg_hi:[0,1,0]
    v_pk_fma_f32 v[108:109], v[76:77], v[114:115], v[58:59] op_sel:[0,1,0] op_sel_hi:[1,1,0] neg_lo:[0,1,0] neg_hi:[0,1,0]
    v_pk_fma_f32 v[110:111], v[78:79], v[114:115], v[58:59] op_sel:[0,1,0] op_sel_hi:[1,1,0] neg_lo:[0,1,0] neg_hi:[0,1,0]
    v_exp_f32 v80, v80
    v_exp_f32 v81, v81
    v_exp_f32 v82, v82
    v_exp_f32 v83, v83
    v_exp_f32 v84, v84
    v_exp_f32 v85, v85
    v_exp_f32 v86, v86
    v_exp_f32 v87, v87
    v_exp_f32 v88, v88
    v_exp_f32 v89, v89
    v_exp_f32 v90, v90
    v_exp_f32 v91, v91
    v_exp_f32 v92, v92
    v_exp_f32 v93, v93
    v_exp_f32 v94, v94
    v_exp_f32 v95, v95
    v_exp_f32 v96, v96
    v_exp_f32 v97, v97
    v_exp_f32 v98, v98
    v_exp_f32 v99, v99
    v_exp_f32 v100, v100
    v_exp_f32 v101, v101
    v_exp_f32 v102, v102
    v_exp_f32 v103, v103
    v_exp_f32 v104, v104
    v_exp_f32 v105, v105
    v_exp_f32 v106, v106
    v_exp_f32 v107, v107
    v_exp_f32 v108, v108
    ds_read_b32 v15, v10 offset:36
    v_exp_f32 v109, v109
    v_exp_f32 v110, v110
    v_exp_f32 v111, v111
    v_pk_add_f32 v[64:65], v[80:81], v[82:83]
    v_pk_add_f32 v[66:67], v[84:85], v[86:87]
    v_pk_add_f32 v[68:69], v[88:89], v[90:91]
    v_pk_add_f32 v[70:71], v[92:93], v[94:95]
    v_pk_add_f32 v[72:73], v[96:97], v[98:99]
    v_pk_add_f32 v[74:75], v[100:101], v[102:103]
    v_pk_add_f32 v[76:77], v[104:105], v[106:107]
    v_pk_add_f32 v[78:79], v[108:109], v[110:111]
    v_pk_add_f32 v[64:65], v[64:65], v[66:67]
    v_pk_add_f32 v[68:69], v[68:69], v[70:71]
    v_pk_add_f32 v[72:73], v[72:73], v[74:75]
    v_pk_add_f32 v[76:77], v[76:77], v[78:79]
    v_pk_add_f32 v[64:65], v[64:65], v[68:69]
    v_pk_add_f32 v[72:73], v[72:73], v[76:77]
    v_add_f32 v64, v64, v65
    v_add_f32 v72, v72, v73
    v_rcp_f32 v60, v64
    v_rcp_f32 v62, v72
    v_pk_mul_f32 v[80:81], v[80:81], v[60:61] op_sel_hi:[1,0]
    v_pk_mul_f32 v[82:83], v[82:83], v[60:61] op_sel_hi:[1,0]
    v_pk_mul_f32 v[84:85], v[84:85], v[60:61] op_sel_hi:[1,0]
    v_pk_mul_f32 v[86:87], v[86:87], v[60:61] op_sel_hi:[1,0]
    v_pk_mul_f32 v[88:89], v[88:89], v[60:61] op_sel_hi:[1,0]
    v_pk_mul_f32 v[90:91], v[90:91], v[60:61] op_sel_hi:[1,0]
    v_pk_mul_f32 v[92:93], v[92:93], v[60:61] op_sel_hi:[1,0]
    v_pk_mul_f32 v[94:95], v[94:95], v[60:61] op_sel_hi:[1,0]
    v_pk_mul_f32 v[96:97], v[96:97], v[62:63] op_sel_hi:[1,0]
    v_pk_mul_f32 v[98:99], v[98:99], v[62:63] op_sel_hi:[1,0]
    v_pk_mul_f32 v[100:101], v[100:101], v[62:63] op_sel_hi:[1,0]
    v_pk_mul_f32 v[102:103], v[102:103], v[62:63] op_sel_hi:[1,0]
    v_pk_mul_f32 v[104:105], v[104:105], v[62:63] op_sel_hi:[1,0]
    v_pk_mul_f32 v[106:107], v[106:107], v[62:63] op_sel_hi:[1,0]
    v_pk_mul_f32 v[108:109], v[108:109], v[62:63] op_sel_hi:[1,0]
    v_pk_mul_f32 v[110:111], v[110:111], v[62:63] op_sel_hi:[1,0]
    v_cvt_pk_bf16_f32 v64, v80, v81
    v_cvt_pk_bf16_f32 v65, v82, v83
    v_cvt_pk_bf16_f32 v66, v84, v85
    v_cvt_pk_bf16_f32 v67, v86, v87
    v_cvt_pk_bf16_f32 v68, v88, v89
    v_cvt_pk_bf16_f32 v69, v90, v91
    v_cvt_pk_bf16_f32 v70, v92, v93
    v_cvt_pk_bf16_f32 v71, v94, v95
    v_cvt_pk_bf16_f32 v72, v96, v97
    v_cvt_pk_bf16_f32 v73, v98, v99
    v_cvt_pk_bf16_f32 v74, v100, v101
    v_cvt_pk_bf16_f32 v75, v102, v103
    v_cvt_pk_bf16_f32 v76, v104, v105
    v_cvt_pk_bf16_f32 v77, v106, v107
    v_cvt_pk_bf16_f32 v78, v108, v109
    v_cvt_pk_bf16_f32 v79, v110, v111
    s_waitcnt lgkmcnt(0)
    v_readfirstlane_b32 s76, v15
    s_nop 0
    s_cmp_ge_u32 s76, s55
    s_cbranch_scc1 L_cf37
    s_mov_b32 s56, 4000000
L_lw38:
    ds_read_b32 v15, v10 offset:36
    s_waitcnt lgkmcnt(0)
    v_readfirstlane_b32 s76, v15
    s_nop 0
    s_cmp_ge_u32 s76, s55
    s_cbranch_scc1 L_lwd38
    s_sub_u32 s56, s56, 1
    s_cbranch_scc0 L_lw38
L_lwd38:
L_cf37:
    ds_write_b128 v41, v[48:51]
    ds_write_b128 v41, v[52:55] offset:4096
    ds_write_b128 v42, v[64:67] offset:0
    ds_write_b128 v42, v[68:71] offset:16
    ds_write_b128 v42, v[72:75] offset:4096
    ds_write_b128 v42, v[76:79] offset:4112
    s_mov_b64 exec, 1
    ds_add_u32 v10, v11 offset:56
    s_mov_b64 exec, -1
    s_and_b32 s73, s72, 1
    s_lshr_b32 s74, s72, 1
    s_mul_i32 s75, s73, 12288
    s_lshl_b32 s54, s74, 12
    s_add_u32 s75, s75, s54
    s_add_u32 s75, s75, 65536
    s_lshl_b32 s54, s73, 12
    s_add_u32 s54, s54, 90112
    v_bfe_u32 v43, v1, 4, 2
    v_lshlrev_b32 v43, 7, v43
    v_bfe_u32 v15, v1, 2, 2
    v_lshl_add_u32 v43, v15, 5, v43
    v_and_b32 v15, 3, v1
    v_lshl_add_u32 v43, v15, 3, v43
    v_add_u32 v44, s54, v43
    v_add_u32 v43, s75, v43
    v_bfe_u32 v45, v1, 4, 2
    v_lshlrev_b32 v45, 4, v45
    v_and_b32 v15, 1, v1
    v_lshl_add_u32 v45, v15, 6, v45
    v_add_u32 v45, 1024, v45
    v_mov_b32 v56, 0x3f803f80
    v_mov_b32 v57, 0x3f803f80
    v_mov_b32 v58, 0x3f803f80
    v_mov_b32 v59, 0x3f803f80
    s_mov_b32 s56, 4000000
L_lw39:
    ds_read_b32 v15, v10 offset:56
    s_waitcnt lgkmcnt(0)
    v_readfirstlane_b32 s76, v15
    s_nop 0
    s_cmp_ge_u32 s76, s55
    s_cbranch_scc1 L_lwd39
    s_sub_u32 s56, s56, 1
    s_cbranch_scc0 L_lw39
L_lwd39:
    ds_read_b64_tr_b16 v[80:81], v43 offset:0
    ds_read_b64_tr_b16 v[82:83], v43 offset:512
    ds_read_b64_tr_b16 v[96:97], v44 offset:0
    ds_read_b64_tr_b16 v[98:99], v44 offset:512
    ds_read_b64_tr_b16 v[84:85], v43 offset:1024
    ds_read_b64_tr_b16 v[86:87], v43 offset:1536
    ds_read_b64_tr_b16 v[100:101], v44 offset:1024
    ds_read_b64_tr_b16 v[102:103], v44 offset:1536
    ds_read_b64_tr_b16 v[88:89], v43 offset:2048
    ds_read_b64_tr_b16 v[90:91], v43 offset:2560
    ds_read_b64_tr_b16 v[104:105], v44 offset:2048
    ds_read_b64_tr_b16 v[106:107], v44 offset:2560
    ds_read_b64_tr_b16 v[92:93], v43 offset:3072
    ds_read_b64_tr_b16 v[94:95], v43 offset:3584
    ds_read_b64_tr_b16 v[108:109], v44 offset:3072
    ds_read_b64_tr_b16 v[110:111], v44 offset:3584
    s_waitcnt lgkmcnt(12)
    v_mfma_f32_16x16x32_bf16 v[64:67], v[80:83], v[96:99], 0
    v_mfma_f32_16x16x32_bf16 v[68:71], v[80:83], v[56:59], 0
    s_waitcnt lgkmcnt(8)
    v_mfma_f32_16x16x32_bf16 v[64:67], v[84:87], v[100:103], v[64:67]
    v_mfma_f32_16x16x32_bf16 v[68:71], v[84:87], v[56:59], v[68:71]
    s_waitcnt lgkmcnt(4)
    v_mfma_f32_16x16x32_bf16 v[64:67], v[88:91], v[104:107], v[64:67]
    v_mfma_f32_16x16x32_bf16 v[68:71], v[88:91], v[56:59], v[68:71]
    s_waitcnt lgkmcnt(0)
    v_mfma_f32_16x16x32_bf16 v[64:67], v[92:95], v[108:111], v[64:67]
    v_mfma_f32_16x16x32_bf16 v[68:71], v[92:95], v[56:59], v[68:71]
    s_nop 6
    buffer_store_dwordx4 v[64:67], v2, s[40:43], s60 offen sc1
    s_mov_b32 s100, 0x00030003
    s_mov_b32 s101, 0x00030003
    s_mov_b64 exec, s[100:101]
    buffer_store_dwordx4 v[68:71], v45, s[40:43], s60 offen sc1
    s_mov_b64 exec, -1
    v_cmp_eq_u32 vcc, 0, v246
    s_nop 1
    s_cbranch_vccz L_A_gotnon
    v_and_b32 v40, 15, v1
    v_lshlrev_b32 v40, 4, v40
    s_mov_b32 s56, 200000
L_A_non:
    buffer_load_dword v246, v40, s[36:39], 0 offen sc1
    s_waitcnt vmcnt(0)
    v_cmp_eq_u32 vcc, 0, v246
    s_nop 1
    s_cbranch_vccz L_A_gotnon
    s_sub_u32 s56, s56, 1
    s_cbranch_scc0 L_A_non
L_A_gotnon:
    s_sub_u32 s75, s63, 34865152
    s_lshr_b32 s75, s75, 11
    s_lshl_b32 s75, s75, 11
    v_and_b32 v40, 15, v1
    v_lshlrev_b32 v40, 7, v40
    v_add_u32 v40, 34865152, v40
    v_add_u32 v40, s75, v40
    v_add_u32 v41, s53, v246
    ds_read_b64_tr_b16 v[48:49], v3 offset:0
    ds_read_b64_tr_b16 v[50:51], v4 offset:0
    ds_read_b64_tr_b16 v[52:53], v5 offset:0
    ds_read_b64_tr_b16 v[54:55], v6 offset:0
    ds_read_b64_tr_b16 v[56:57], v3 offset:2048
    ds_read_b64_tr_b16 v[58:59], v4 offset:2048
    s_waitcnt lgkmcnt(4)
    v_mfma_f32_32x32x16_bf16 v[80:95], v[48:51], v[116:119], 0
    ds_read_b64_tr_b16 v[60:61], v5 offset:2048
    ds_read_b64_tr_b16 v[62:63], v6 offset:2048
    s_waitcnt lgkmcnt(4)
    v_mfma_f32_32x32x16_bf16 v[80:95], v[52:55], v[120:123], v[80:95]
    ds_read_b64_tr_b16 v[48:49], v3 offset:12288
    ds_read_b64_tr_b16 v[50:51], v4 offset:12288
    s_waitcnt lgkmcnt(4)
    v_mfma_f32_32x32x16_bf16 v[80:95], v[56:59], v[124:127], v[80:95]
    ds_read_b64_tr_b16 v[52:53], v5 offset:12288
    ds_read_b64_tr_b16 v[54:55], v6 offset:12288
    s_waitcnt lgkmcnt(4)
    v_mfma_f32_32x32x16_bf16 v[80:95], v[60:63], v[128:131], v[80:95]
    ds_read_b64_tr_b16 v[56:57], v3 offset:14336
    ds_read_b64_tr_b16 v[58:59], v4 offset:14336
    s_waitcnt lgkmcnt(4)
    v_mfma_f32_32x32x16_bf16 v[80:95], v[48:51], v[132:135], v[80:95]
    ds_read_b64_tr_b16 v[60:61], v5 offset:14336
    ds_read_b64_tr_b16 v[62:63], v6 offset:14336
    s_waitcnt lgkmcnt(4)
    v_mfma_f32_32x32x16_bf16 v[80:95], v[52:55], v[136:139], v[80:95]
    ds_read_b64_tr_b16 v[48:49], v3 offset:24576
    ds_read_b64_tr_b16 v[50:51], v4 offset:24576
    s_waitcnt lgkmcnt(4)
    v_mfma_f32_32x32x16_bf16 v[80:95], v[56:59], v[140:143], v[80:95]
    ds_read_b64_tr_b16 v[52:53], v5 offset:24576
    ds_read_b64_tr_b16 v[54:55], v6 offset:24576
    s_waitcnt lgkmcnt(4)
    v_mfma_f32_32x32x16_bf16 v[80:95], v[60:63], v[144:147], v[80:95]
    ds_read_b64_tr_b16 v[56:57], v3 offset:26624
    ds_read_b64_tr_b16 v[58:59], v4 offset:26624
    s_waitcnt lgkmcnt(4)
    v_mfma_f32_32x32x16_bf16 v[80:95], v[48:51], v[148:151], v[80:95]
    ds_read_b64_tr_b16 v[60:61], v5 offset:26624
    ds_read_b64_tr_b16 v[62:63], v6 offset:26624
    s_waitcnt lgkmcnt(4)
    v_mfma_f32_32x32x16_bf16 v[80:95], v[52:55], v[152:155], v[80:95]
    ds_read_b64_tr_b16 v[48:49], v3 offset:36864
    ds_read_b64_tr_b16 v[50:51], v4 offset:36864
    s_waitcnt lgkmcnt(4)
    v_mfma_f32_32x32x16_bf16 v[80:95], v[56:59], v[156:159], v[80:95]
    ds_read_b64_tr_b16 v[52:53], v5 offset:36864
    ds_read_b64_tr_b16 v[54:55], v6 offset:36864
    s_waitcnt lgkmcnt(4)
    v_mfma_f32_32x32x16_bf16 v[80:95], v[60:63], v[160:163], v[80:95]
    ds_read_b64_tr_b16 v[56:57], v3 offset:38912
    ds_read_b64_tr_b16 v[58:59], v4 offset:38912
    s_waitcnt lgkmcnt(4)
    v_mfma_f32_32x32x16_bf16 v[80:95], v[48:51], v[164:167], v[80:95]
    ds_read_b64_tr_b16 v[60:61], v5 offset:38912
    ds_read_b64_tr_b16 v[62:63], v6 offset:38912
    s_waitcnt lgkmcnt(4)
    v_mfma_f32_32x32x16_bf16 v[80:95], v[52:55], v[168:171], v[80:95]
    ds_read_b64_tr_b16 v[48:49], v3 offset:49152
    ds_read_b64_tr_b16 v[50:51], v4 offset:49152
    s_waitcnt lgkmcnt(4)
    v_mfma_f32_32x32x16_bf16 v[80:95], v[56:59], v[172:175], v[80:95]
    ds_read_b64_tr_b16 v[52:53], v5 offset:49152
    ds_read_b64_tr_b16 v[54:55], v6 offset:49152
    s_waitcnt lgkmcnt(4)
    v_mfma_f32_32x32x16_bf16 v[80:95], v[60:63], v[176:179], v[80:95]
    ds_read_b64_tr_b16 v[56:57], v3 offset:51200
    ds_read_b64_tr_b16 v[58:59], v4 offset:51200
    s_waitcnt lgkmcnt(4)
    v_mfma_f32_32x32x16_bf16 v[80:95], v[48:51], v[180:183], v[80:95]
    ds_read_b64_tr_b16 v[60:61], v5 offset:51200
    ds_read_b64_tr_b16 v[62:63], v6 offset:51200
    s_mov_b64 exec, 1
    ds_add_u32 v10, v11 offset:52
    s_mov_b64 exec, -1
    s_waitcnt lgkmcnt(5)
    v_mfma_f32_32x32x16_bf16 v[80:95], v[52:55], v[184:187], v[80:95]
    v_add_u32 v3, 61440, v3
    v_add_u32 v4, 61440, v4
    v_add_u32 v5, 61440, v5
    v_add_u32 v6, 61440, v6
    ds_read_b64_tr_b16 v[48:49], v3 offset:0
    ds_read_b64_tr_b16 v[50:51], v4 offset:0
    s_waitcnt lgkmcnt(5)
    v_mfma_f32_32x32x16_bf16 v[80:95], v[56:59], v[188:191], v[80:95]
    ds_read_b64_tr_b16 v[52:53], v5 offset:0
    ds_read_b64_tr_b16 v[54:55], v6 offset:0
    s_add_u32 s65, s64, s53
    v_mov_b32 v15, s65
    v_lshlrev_b32 v255, 2, v1
    s_waitcnt vmcnt(0)
    s_mov_b32 exec_hi, 0
    buffer_store_dword v15, v255, s[40:43], s63 offen sc1
    s_mov_b32 exec_hi, -1
    s_waitcnt lgkmcnt(5)
    v_mfma_f32_32x32x16_bf16 v[80:95], v[60:63], v[192:195], v[80:95]
    ds_read_b64_tr_b16 v[56:57], v3 offset:2048
    ds_read_b64_tr_b16 v[58:59], v4 offset:2048
    s_waitcnt lgkmcnt(4)
    v_mfma_f32_32x32x16_bf16 v[80:95], v[48:51], v[196:199], v[80:95]
    ds_read_b64_tr_b16 v[60:61], v5 offset:2048
    ds_read_b64_tr_b16 v[62:63], v6 offset:2048
    s_waitcnt lgkmcnt(4)
    v_mfma_f32_32x32x16_bf16 v[80:95], v[52:55], v[200:203], v[80:95]
    ds_read_b64_tr_b16 v[48:49], v3 offset:12288
    ds_read_b64_tr_b16 v[50:51], v4 offset:12288
    s_waitcnt lgkmcnt(4)
    v_mfma_f32_32x32x16_bf16 v[80:95], v[56:59], v[204:207], v[80:95]
    ds_read_b64_tr_b16 v[52:53], v5 offset:12288
    ds_read_b64_tr_b16 v[54:55], v6 offset:12288
    s_waitcnt lgkmcnt(4)
    v_mfma_f32_32x32x16_bf16 v[80:95], v[60:63], v[208:211], v[80:95]
    ds_read_b64_tr_b16 v[56:57], v3 offset:14336
    ds_read_b64_tr_b16 v[58:59], v4 offset:14336
    s_waitcnt lgkmcnt(4)
    v_mfma_f32_32x32x16_bf16 v[80:95], v[48:51], v[212:215], v[80:95]
    ds_read_b64_tr_b16 v[60:61], v5 offset:14336
    ds_read_b64_tr_b16 v[62:63], v6 offset:14336
    s_waitcnt lgkmcnt(4)
    v_mfma_f32_32x32x16_bf16 v[80:95], v[52:55], v[216:219], v[80:95]
    ds_read_b64_tr_b16 v[48:49], v3 offset:24576
    ds_read_b64_tr_b16 v[50:51], v4 offset:24576
    s_waitcnt lgkmcnt(4)
    v_mfma_f32_32x32x16_bf16 v[80:95], v[56:59], v[220:223], v[80:95]
    ds_read_b64_tr_b16 v[52:53], v5 offset:24576
    ds_read_b64_tr_b16 v[54:55], v6 offset:24576
    s_waitcnt lgkmcnt(4)
    v_mfma_f32_32x32x16_bf16 v[80:95], v[60:63], v[224:227], v[80:95]
    ds_read_b64_tr_b16 v[56:57], v3 offset:26624
    ds_read_b64_tr_b16 v[58:59], v4 offset:26624
    s_waitcnt lgkmcnt(4)
    v_mfma_f32_32x32x16_bf16 v[80:95], v[48:51], v[228:231], v[80:95]
    ds_read_b64_tr_b16 v[60:61], v5 offset:26624
    ds_read_b64_tr_b16 v[62:63], v6 offset:26624
    s_waitcnt lgkmcnt(4)
    v_mfma_f32_32x32x16_bf16 v[80:95], v[52:55], v[232:235], v[80:95]
    s_waitcnt lgkmcnt(2)
    v_mfma_f32_32x32x16_bf16 v[80:95], v[56:59], v[236:239], v[80:95]
    s_waitcnt lgkmcnt(0)
    v_mfma_f32_32x32x16_bf16 v[80:95], v[60:63], v[240:243], v[80:95]
    s_mov_b64 exec, 1
    ds_add_u32 v10, v11 offset:60
    s_mov_b64 exec, -1
    v_subrev_u32 v3, 61440, v3
    v_subrev_u32 v4, 61440, v4
    v_subrev_u32 v5, 61440, v5
    v_subrev_u32 v6, 61440, v6
    ds_read_b128 v[96:99], v14 offset:0
    ds_read_b128 v[100:103], v14 offset:32
    ds_read_b128 v[104:107], v14 offset:64
    ds_read_b128 v[108:111], v14 offset:96
    buffer_load_dword v44, v40, s[40:43], 0 offen sc1
    s_waitcnt lgkmcnt(0)
    v_pk_fma_f32 v[80:81], v[96:97], v[114:115], v[80:81] op_sel_hi:[1,0,1]
    v_pk_fma_f32 v[82:83], v[98:99], v[114:115], v[82:83] op_sel_hi:[1,0,1]
    v_pk_fma_f32 v[84:85], v[100:101], v[114:115], v[84:85] op_sel_hi:[1,0,1]
    v_pk_fma_f32 v[86:87], v[102:103], v[114:115], v[86:87] op_sel_hi:[1,0,1]
    v_pk_fma_f32 v[88:89], v[104:105], v[114:115], v[88:89] op_sel_hi:[1,0,1]
    v_pk_fma_f32 v[90:91], v[106:107], v[114:115], v[90:91] op_sel_hi:[1,0,1]
    v_pk_fma_f32 v[92:93], v[108:109], v[114:115], v[92:93] op_sel_hi:[1,0,1]
    v_pk_fma_f32 v[94:95], v[110:111], v[114:115], v[94:95] op_sel_hi:[1,0,1]
    v_cvt_pk_bf16_f32 v48, v80, v81
    v_cvt_pk_bf16_f32 v49, v82, v83
    v_cvt_pk_bf16_f32 v50, v84, v85
    v_cvt_pk_bf16_f32 v51, v86, v87
    v_cvt_pk_bf16_f32 v52, v88, v89
    v_cvt_pk_bf16_f32 v53, v90, v91
    v_cvt_pk_bf16_f32 v54, v92, v93
    v_cvt_pk_bf16_f32 v55, v94, v95
    v_mfma_f32_32x32x16_bf16 v[64:79], v[32:35], v[48:51], 0
    s_nop 0
    v_mfma_f32_32x32x16_bf16 v[64:79], v[36:39], v[52:55], v[64:79]
    s_lshl_b32 s75, s73, 10
    s_lshl_b32 s54, s74, 5
    s_add_u32 s75, s75, s54
    v_bfe_u32 v42, v1, 2, 1
    v_lshlrev_b32 v42, 9, v42
    v_bfe_u32 v15, v1, 3, 1
    v_lshl_add_u32 v42, v15, 8, v42
    v_and_b32 v15, 3, v1
    v_lshl_add_u32 v42, v15, 6, v42
    v_bfe_u32 v15, v1, 4, 2
    v_lshl_add_u32 v42, v15, 3, v42
    v_add_u32 v42, 65536, v42
    v_add_u32 v42, s75, v42
    s_lshl_b32 s75, s73, 6
    s_add_u32 s75, s75, s54
    v_bfe_u32 v43, v1, 4, 2
    v_lshlrev_b32 v43, 3, v43
    v_add_u32 v43, 67584, v43
    v_add_u32 v43, s75, v43
    v_and_b32 v46, 31, v1
    v_lshlrev_b32 v46, 6, v46
    v_add_u32 v46, 65536, v46
    v_bfe_u32 v47, v1, 5, 1
    v_lshlrev_b32 v47, 6, v47
    v_add_u32 v47, 67584, v47
    v_max3_f32 v56, v64, v65, v66
    v_min3_f32 v58, v64, v65, v66
    v_max3_f32 v56, v56, v67, v68
    v_min3_f32 v58, v58, v67, v68
    v_max3_f32 v56, v56, v69, v70
    v_min3_f32 v58, v58, v69, v70
    v_max3_f32 v56, v56, v71, v72
    v_min3_f32 v58, v58, v71, v72
    v_max3_f32 v56, v56, v73, v74
    v_min3_f32 v58, v58, v73, v74
    v_max3_f32 v56, v56, v75, v76
    v_min3_f32 v58, v58, v75, v76
    v_max3_f32 v56, v56, v77, v78
    v_min3_f32 v58, v58, v77, v78
    v_max_f32 v56, v56, v79
    v_min_f32 v58, v58, v79
    v_mul_f32 v56, v115, v56
    v_mul_f32 v58, v115, v58
    v_pk_fma_f32 v[80:81], v[64:65], v[114:115], v[56:57] op_sel:[0,1,0] op_sel_hi:[1,1,0] neg_lo:[0,0,1] neg_hi:[0,0,1]
    v_pk_fma_f32 v[82:83], v[66:67], v[114:115], v[56:57] op_sel:[0,1,0] op_sel_hi:[1,1,0] neg_lo:[0,0,1] neg_hi:[0,0,1]
    v_pk_fma_f32 v[84:85], v[68:69], v[114:115], v[56:57] op_sel:[0,1,0] op_sel_hi:[1,1,0] neg_lo:[0,0,1] neg_hi:[0,0,1]
    v_pk_fma_f32 v[86:87], v[70:71], v[114:115], v[56:57] op_sel:[0,1,0] op_sel_hi:[1,1,0] neg_lo:[0,0,1] neg_hi:[0,0,1]
    v_pk_fma_f32 v[88:89], v[72:73], v[114:115], v[56:57] op_sel:[0,1,0] op_sel_hi:[1,1,0] neg_lo:[0,0,1] neg_hi:[0,0,1]
    v_pk_fma_f32 v[90:91], v[74:75], v[114:115], v[56:57] op_sel:[0,1,0] op_sel_hi:[1,1,0] neg_lo:[0,0,1] neg_hi:[0,0,1]
    v_pk_fma_f32 v[92:93], v[76:77], v[114:115], v[56:57] op_sel:[0,1,0] op_sel_hi:[1,1,0] neg_lo:[0,0,1] neg_hi:[0,0,1]
    v_pk_fma_f32 v[94:95], v[78:79], v[114:115], v[56:57] op_sel:[0,1,0] op_sel_hi:[1,1,0] neg_lo:[0,0,1] neg_hi:[0,0,1]
    v_pk_fma_f32 v[96:97], v[64:65], v[114:115], v[58:59] op_sel:[0,1,0] op_sel_hi:[1,1,0] neg_lo:[0,1,0] neg_hi:[0,1,0]
    v_pk_fma_f32 v[98:99], v[66:67], v[114:115], v[58:59] op_sel:[0,1,0] op_sel_hi:[1,1,0] neg_lo:[0,1,0] neg_hi:[0,1,0]
    v_pk_fma_f32 v[100:101], v[68:69], v[114:115], v[58:59] op_sel:[0,1,0] op_sel_hi:[1,1,0] neg_lo:[0,1,0] neg_hi:[0,1,0]
    v_pk_fma_f32 v[102:103], v[70:71], v[114:115], v[58:59] op_sel:[0,1,0] op_sel_hi:[1,1,0] neg_lo:[0,1,0] neg_hi:[0,1,0]
    v_pk_fma_f32 v[104:105], v[72:73], v[114:115], v[58:59] op_sel:[0,1,0] op_sel_hi:[1,1,0] neg_lo:[0,1,0] neg_hi:[0,1,0]
    v_pk_fma_f32 v[106:107], v[74:75], v[114:115], v[58:59] op_sel:[0,1,0] op_sel_hi:[1,1,0] neg_lo:[0,1,0] neg_hi:[0,1,0]
    v_pk_fma_f32 v[108:109], v[76:77], v[114:115], v[58:59] op_sel:[0,1,0] op_sel_hi:[1,1,0] neg_lo:[0,1,0] neg_hi:[0,1,0]
    v_pk_fma_f32 v[110:111], v[78:79], v[114:115], v[58:59] op_sel:[0,1,0] op_sel_hi:[1,1,0] neg_lo:[0,1,0] neg_hi:[0,1,0]
    v_exp_f32 v80, v80
    v_exp_f32 v81, v81
    v_exp_f32 v82, v82
    v_exp_f32 v83, v83
    v_exp_f32 v84, v84
    v_exp_f32 v85, v85
    v_exp_f32 v86, v86
    v_exp_f32 v87, v87
    v_exp_f32 v88, v88
    s_waitcnt vmcnt(0)
    v_sub_u32 v44, v44, v41
    v_cmp_le_u32 vcc, 8, v44
    s_mov_b32 s67, 0
    s_cbranch_vccnz L_A_notyet
    s_mov_b32 s67, 1
    s_mov_b32 s54, s68
    buffer_load_dwordx4 v[116:119], v2, s[40:43], s54 offen
    buffer_load_dwordx4 v[180:183], v45, s[40:43], s54 offen
    s_add_u32 s54, s54, 1152
    buffer_load_dwordx4 v[120:123], v2, s[40:43], s54 offen
    buffer_load_dwordx4 v[184:187], v45, s[40:43], s54 offen
    s_add_u32 s54, s54, 1152
    buffer_load_dwordx4 v[124:127], v2, s[40:43], s54 offen
    buffer_load_dwordx4 v[188:191], v45, s[40:43], s54 offen
    s_add_u32 s54, s54, 1152
    buffer_load_dwordx4 v[128:131], v2, s[40:43], s54 offen
    buffer_load_dwordx4 v[192:195], v45, s[40:43], s54 offen
    s_add_u32 s54, s54, 1152
    buffer_load_dwordx4 v[132:135], v2, s[40:43], s54 offen
    buffer_load_dwordx4 v[196:199], v45, s[40:43], s54 offen
    s_add_u32 s54, s54, 1152
    buffer_load_dwordx4 v[136:139], v2, s[40:43], s54 offen
    buffer_load_dwordx4 v[200:203], v45, s[40:43], s54 offen
    s_add_u32 s54, s54, 1152
    buffer_load_dwordx4 v[140:143], v2, s[40:43], s54 offen
    buffer_load_dwordx4 v[204:207], v45, s[40:43], s54 offen
    s_add_u32 s54, s54, 1152
    buffer_load_dwordx4 v[144:147], v2, s[40:43], s54 offen
    buffer_load_dwordx4 v[208:211], v45, s[40:43], s54 offen
    s_add_u32 s54, s54, 1152
    buffer_load_dwordx4 v[148:151], v2, s[40:43], s54 offen
    buffer_load_dwordx4 v[212:215], v45, s[40:43], s54 offen
    s_add_u32 s54, s54, 1152
    buffer_load_dwordx4 v[152:155], v2, s[40:43], s54 offen
    buffer_load_dwordx4 v[216:219], v45, s[40:43], s54 offen
    s_add_u32 s54, s54, 1152
    buffer_load_dwordx4 v[156:159], v2, s[40:43], s54 offen
    buffer_load_dwordx4 v[220:223], v45, s[40:43], s54 offen
    s_add_u32 s54, s54, 1152
    buffer_load_dwordx4 v[160:163], v2, s[40:43], s54 offen
    buffer_load_dwordx4 v[224:227], v45, s[40:43], s54 offen
    s_add_u32 s54, s54, 1152
    buffer_load_dwordx4 v[164:167], v2, s[40:43], s54 offen
    buffer_load_dwordx4 v[228:231], v45, s[40:43], s54 offen
    s_add_u32 s54, s54, 1152
    buffer_load_dwordx4 v[168:171], v2, s[40:43], s54 offen
    buffer_load_dwordx4 v[232:235], v45, s[40:43], s54 offen
    s_add_u32 s54, s54, 1152
    buffer_load_dwordx4 v[172:175], v2, s[40:43], s54 offen
    buffer_load_dwordx4 v[236:239], v45, s[40:43], s54 offen
    s_add_u32 s54, s54, 1152
    buffer_load_dwordx4 v[176:179], v2, s[40:43], s54 offen
    buffer_load_dwordx4 v[240:243], v45, s[40:43], s54 offen
L_A_notyet:
    v_exp_f32 v89, v89
    v_exp_f32 v90, v90
    v_exp_f32 v91, v91
    v_exp_f32 v92, v92
    v_exp_f32 v93, v93
    v_exp_f32 v94, v94
    v_exp_f32 v95, v95
    v_exp_f32 v96, v96
    v_exp_f32 v97, v97
    v_exp_f32 v98, v98
    v_exp_f32 v99, v99
    v_exp_f32 v100, v100
    v_exp_f32 v101, v101
    v_exp_f32 v102, v102
    v_exp_f32 v103, v103
    v_exp_f32 v104, v104
    v_exp_f32 v105, v105
    v_exp_f32 v106, v106
    v_exp_f32 v107, v107
    v_exp_f32 v108, v108
    v_exp_f32 v109, v109
    v_exp_f32 v110, v110
    v_exp_f32 v111, v111
    v_pk_add_f32 v[64:65], v[80:81], v[82:83]
    v_pk_add_f32 v[66:67], v[84:85], v[86:87]
    v_pk_add_f32 v[68:69], v[88:89], v[90:91]
    v_pk_add_f32 v[70:71], v[92:93], v[94:95]
    v_pk_add_f32 v[72:73], v[96:97], v[98:99]
    v_pk_add_f32 v[74:75], v[100:101], v[102:103]
    v_pk_add_f32 v[76:77], v[104:105], v[106:107]
    v_pk_add_f32 v[78:79], v[108:109], v[110:111]
    v_pk_add_f32 v[64:65], v[64:65], v[66:67]
    v_pk_add_f32 v[68:69], v[68:69], v[70:71]
    v_pk_add_f32 v[72:73], v[72:73], v[74:75]
    v_pk_add_f32 v[76:77], v[76:77], v[78:79]
    v_pk_add_f32 v[64:65], v[64:65], v[68:69]
    v_pk_add_f32 v[72:73], v[72:73], v[76:77]
    v_add_f32 v64, v64, v65
    v_add_f32 v72, v72, v73
    v_rcp_f32 v60, v64
    v_rcp_f32 v62, v72
    v_pk_mul_f32 v[80:81], v[80:81], v[60:61] op_sel_hi:[1,0]
    v_pk_mul_f32 v[82:83], v[82:83], v[60:61] op_sel_hi:[1,0]
    v_pk_mul_f32 v[84:85], v[84:85], v[60:61] op_sel_hi:[1,0]
    v_pk_mul_f32 v[86:87], v[86:87], v[60:61] op_sel_hi:[1,0]
    v_pk_mul_f32 v[88:89], v[88:89], v[60:61] op_sel_hi:[1,0]
    v_pk_mul_f32 v[90:91], v[90:91], v[60:61] op_sel_hi:[1,0]
    v_pk_mul_f32 v[92:93], v[92:93], v[60:61] op_sel_hi:[1,0]
    v_pk_mul_f32 v[94:95], v[94:95], v[60:61] op_sel_hi:[1,0]
    v_pk_mul_f32 v[96:97], v[96:97], v[62:63] op_sel_hi:[1,0]
    v_pk_mul_f32 v[98:99], v[98:99], v[62:63] op_sel_hi:[1,0]
    v_pk_mul_f32 v[100:101], v[100:101], v[62:63] op_sel_hi:[1,0]
    v_pk_mul_f32 v[102:103], v[102:103], v[62:63] op_sel_hi:[1,0]
    v_pk_mul_f32 v[104:105], v[104:105], v[62:63] op_sel_hi:[1,0]
    v_pk_mul_f32 v[106:107], v[106:107], v[62:63] op_sel_hi:[1,0]
    v_pk_mul_f32 v[108:109], v[108:109], v[62:63] op_sel_hi:[1,0]
    v_pk_mul_f32 v[110:111], v[110:111], v[62:63] op_sel_hi:[1,0]
    v_cvt_pk_bf16_f32 v64, v80, v81
    v_cvt_pk_bf16_f32 v65, v82, v83
    v_cvt_pk_bf16_f32 v66, v84, v85
    v_cvt_pk_bf16_f32 v67, v86, v87
    v_cvt_pk_bf16_f32 v68, v88, v89
    v_cvt_pk_bf16_f32 v69, v90, v91
    v_cvt_pk_bf16_f32 v70, v92, v93
    v_cvt_pk_bf16_f32 v71, v94, v95
    v_cvt_pk_bf16_f32 v72, v96, v97
    v_cvt_pk_bf16_f32 v73, v98, v99
    v_cvt_pk_bf16_f32 v74, v100, v101
    v_cvt_pk_bf16_f32 v75, v102, v103
    v_cvt_pk_bf16_f32 v76, v104, v105
    v_cvt_pk_bf16_f32 v77, v106, v107
    v_cvt_pk_bf16_f32 v78, v108, v109
    v_cvt_pk_bf16_f32 v79, v110, v111
    s_cmp_lg_u32 s67, 0
    s_cbranch_scc1 L_A_haveK
    s_mov_b32 s56, 200000
    s_mov_b64 exec, 0xffff
    s_mov_b32 s76, 1
L_poll_K:
    buffer_load_dword v15, v40, s[40:43], 0 offen sc1
    s_waitcnt vmcnt(0)
    v_subrev_u32 v15, v41, v15
    v_cmp_le_u32 vcc, 8, v15
    s_nop 1
    s_cbranch_vccnz L_pollmore_K
    s_cmp_lg_u32 s76, 0
    s_cbranch_scc1 L_polldone_K
    s_mov_b32 s76, 1
    s_mov_b64 exec, 0xffff
    s_branch L_poll_K
L_pollmore_K:
    s_mov_b64 exec, vcc
    s_sub_u32 s56, s56, 1
    s_cbranch_scc0 L_poll_K
L_polldone_K:
    s_mov_b64 exec, -1
    s_mov_b32 s54, s68
    buffer_load_dwordx4 v[116:119], v2, s[40:43], s54 offen
    buffer_load_dwordx4 v[180:183], v45, s[40:43], s54 offen
    s_add_u32 s54, s54, 1152
    buffer_load_dwordx4 v[120:123], v2, s[40:43], s54 offen
    buffer_load_dwordx4 v[184:187], v45, s[40:43], s54 offen
    s_add_u32 s54, s54, 1152
    buffer_load_dwordx4 v[124:127], v2, s[40:43], s54 offen
    buffer_load_dwordx4 v[188:191], v45, s[40:43], s54 offen
    s_add_u32 s54, s54, 1152
    buffer_load_dwordx4 v[128:131], v2, s[40:43], s54 offen
    buffer_load_dwordx4 v[192:195], v45, s[40:43], s54 offen
    s_add_u32 s54, s54, 1152
    buffer_load_dwordx4 v[132:135], v2, s[40:43], s54 offen
    buffer_load_dwordx4 v[196:199], v45, s[40:43], s54 offen
    s_add_u32 s54, s54, 1152
    buffer_load_dwordx4 v[136:139], v2, s[40:43], s54 offen
    buffer_load_dwordx4 v[200:203], v45, s[40:43], s54 offen
    s_add_u32 s54, s54, 1152
    buffer_load_dwordx4 v[140:143], v2, s[40:43], s54 offen
    buffer_load_dwordx4 v[204:207], v45, s[40:43], s54 offen
    s_add_u32 s54, s54, 1152
    buffer_load_dwordx4 v[144:147], v2, s[40:43], s54 offen
    buffer_load_dwordx4 v[208:211], v45, s[40:43], s54 offen
    s_add_u32 s54, s54, 1152
    buffer_load_dwordx4 v[148:151], v2, s[40:43], s54 offen
    buffer_load_dwordx4 v[212:215], v45, s[40:43], s54 offen
    s_add_u32 s54, s54, 1152
    buffer_load_dwordx4 v[152:155], v2, s[40:43], s54 offen
    buffer_load_dwordx4 v[216:219], v45, s[40:43], s54 offen
    s_add_u32 s54, s54, 1152
    buffer_load_dwordx4 v[156:159], v2, s[40:43], s54 offen
    buffer_load_dwordx4 v[220:223], v45, s[40:43], s54 offen
    s_add_u32 s54, s54, 1152
    buffer_load_dwordx4 v[160:163], v2, s[40:43], s54 offen
    buffer_load_dwordx4 v[224:227], v45, s[40:43], s54 offen
    s_add_u32 s54, s54, 1152
    buffer_load_dwordx4 v[164:167], v2, s[40:43], s54 offen
    buffer_load_dwordx4 v[228:231], v45, s[40:43], s54 offen
    s_add_u32 s54, s54, 1152
    buffer_load_dwordx4 v[168:171], v2, s[40:43], s54 offen
    buffer_load_dwordx4 v[232:235], v45, s[40:43], s54 offen
    s_add_u32 s54, s54, 1152
    buffer_load_dwordx4 v[172:175], v2, s[40:43], s54 offen
    buffer_load_dwordx4 v[236:239], v45, s[40:43], s54 offen
    s_add_u32 s54, s54, 1152
    buffer_load_dwordx4 v[176:179], v2, s[40:43], s54 offen
    buffer_load_dwordx4 v[240:243], v45, s[40:43], s54 offen
L_A_haveK:
    s_mov_b32 s56, 4000000
L_lw40:
    ds_read_b32 v15, v10 offset:60
    s_waitcnt lgkmcnt(0)
    v_readfirstlane_b32 s76, v15
    s_nop 0
    s_cmp_ge_u32 s76, s46
    s_cbranch_scc1 L_lwd40
    s_sub_u32 s56, s56, 1
    s_cbranch_scc0 L_lw40
L_lwd40:
    v_mov_b32 v80, 0
    v_mov_b32 v81, 0
    v_mov_b32 v82, 0
    v_mov_b32 v83, 0
    v_mov_b32 v84, 0
    v_mov_b32 v85, 0
    v_mov_b32 v86, 0
    v_mov_b32 v87, 0
    v_mov_b32 v88, 0
    v_mov_b32 v89, 0
    v_mov_b32 v90, 0
    v_mov_b32 v91, 0
    v_mov_b32 v92, 0
    v_mov_b32 v93, 0
    v_mov_b32 v94, 0
    v_mov_b32 v95, 0
    v_mov_b32 v96, 0
    v_mov_b32 v97, 0
    v_mov_b32 v98, 0
    v_mov_b32 v99, 0
    v_mov_b32 v100, 0
    v_mov_b32 v101, 0
    v_mov_b32 v102, 0
    v_mov_b32 v103, 0
    v_mov_b32 v104, 0
    v_mov_b32 v105, 0
    v_mov_b32 v106, 0
    v_mov_b32 v107, 0
    v_mov_b32 v108, 0
    v_mov_b32 v109, 0
    v_mov_b32 v110, 0
    v_mov_b32 v111, 0
    s_waitcnt vmcnt(28)
    v_pk_add_f32 v[116:117], v[116:117], v[120:121]
    v_pk_add_f32 v[118:119], v[118:119], v[122:123]
    v_pk_add_f32 v[180:181], v[180:181], v[184:185]
    v_pk_add_f32 v[182:183], v[182:183], v[186:187]
    s_waitcnt vmcnt(26)
    v_pk_add_f32 v[116:117], v[116:117], v[124:125]
    v_pk_add_f32 v[118:119], v[118:119], v[126:127]
    v_pk_add_f32 v[180:181], v[180:181], v[188:189]
    v_pk_add_f32 v[182:183], v[182:183], v[190:191]
    s_waitcnt vmcnt(24)
    v_pk_add_f32 v[116:117], v[116:117], v[128:129]
    v_pk_add_f32 v[118:119], v[118:119], v[130:131]
    v_pk_add_f32 v[180:181], v[180:181], v[192:193]
    v_pk_add_f32 v[182:183], v[182:183], v[194:195]
    s_waitcnt vmcnt(22)
    v_pk_add_f32 v[116:117], v[116:117], v[132:133]
    v_pk_add_f32 v[118:119], v[118:119], v[134:135]
    v_pk_add_f32 v[180:181], v[180:181], v[196:197]
    v_pk_add_f32 v[182:183], v[182:183], v[198:199]
    s_waitcnt vmcnt(20)
    v_pk_add_f32 v[116:117], v[116:117], v[136:137]
    v_pk_add_f32 v[118:119], v[118:119], v[138:139]
    v_pk_add_f32 v[180:181], v[180:181], v[200:201]
    v_pk_add_f32 v[182:183], v[182:183], v[202:203]
    s_waitcnt vmcnt(18)
    v_pk_add_f32 v[116:117], v[116:117], v[140:141]
    v_pk_add_f32 v[118:119], v[118:119], v[142:143]
    v_pk_add_f32 v[180:181], v[180:181], v[204:205]
    v_pk_add_f32 v[182:183], v[182:183], v[206:207]
    s_waitcnt vmcnt(16)
    v_pk_add_f32 v[116:117], v[116:117], v[144:145]
    v_pk_add_f32 v[118:119], v[118:119], v[146:147]
    v_pk_add_f32 v[180:181], v[180:181], v[208:209]
    v_pk_add_f32 v[182:183], v[182:183], v[210:211]
    s_waitcnt vmcnt(14)
    v_pk_add_f32 v[116:117], v[116:117], v[148:149]
    v_pk_add_f32 v[118:119], v[118:119], v[150:151]
    v_pk_add_f32 v[180:181], v[180:181], v[212:213]
    v_pk_add_f32 v[182:183], v[182:183], v[214:215]
    s_waitcnt vmcnt(12)
    v_pk_add_f32 v[116:117], v[116:117], v[152:153]
    v_pk_add_f32 v[118:119], v[118:119], v[154:155]
    v_pk_add_f32 v[180:181], v[180:181], v[216:217]
    v_pk_add_f32 v[182:183], v[182:183], v[218:219]
    s_waitcnt vmcnt(10)
    v_pk_add_f32 v[116:117], v[116:117], v[156:157]
    v_pk_add_f32 v[118:119], v[118:119], v[158:159]
    v_pk_add_f32 v[180:181], v[180:181], v[220:221]
    v_pk_add_f32 v[182:183], v[182:183], v[222:223]
    s_waitcnt vmcnt(8)
    v_pk_add_f32 v[116:117], v[116:117], v[160:161]
    v_pk_add_f32 v[118:119], v[118:119], v[162:163]
    v_pk_add_f32 v[180:181], v[180:181], v[224:225]
    v_pk_add_f32 v[182:183], v[182:183], v[226:227]
    s_waitcnt vmcnt(6)
    v_pk_add_f32 v[116:117], v[116:117], v[164:165]
    v_pk_add_f32 v[118:119], v[118:119], v[166:167]
    v_pk_add_f32 v[180:181], v[180:181], v[228:229]
    v_pk_add_f32 v[182:183], v[182:183], v[230:231]
    s_waitcnt vmcnt(4)
    v_pk_add_f32 v[116:117], v[116:117], v[168:169]
    v_pk_add_f32 v[118:119], v[118:119], v[170:171]
    v_pk_add_f32 v[180:181], v[180:181], v[232:233]
    v_pk_add_f32 v[182:183], v[182:183], v[234:235]
    s_waitcnt vmcnt(2)
    v_pk_add_f32 v[116:117], v[116:117], v[172:173]
    v_pk_add_f32 v[118:119], v[118:119], v[174:175]
    v_pk_add_f32 v[180:181], v[180:181], v[236:237]
    v_pk_add_f32 v[182:183], v[182:183], v[238:239]
    s_waitcnt vmcnt(0)
    v_pk_add_f32 v[116:117], v[116:117], v[176:177]
    v_pk_add_f32 v[118:119], v[118:119], v[178:179]
    v_pk_add_f32 v[180:181], v[180:181], v[240:241]
    v_pk_add_f32 v[182:183], v[182:183], v[242:243]
    v_cvt_pk_bf16_f32 v116, v116, v117
    v_cvt_pk_bf16_f32 v117, v118, v119
    ds_write_b64 v42, v[116:117]
    v_cvt_pk_bf16_f32 v180, v180, v181
    v_cvt_pk_bf16_f32 v181, v182, v183
    ds_write_b64 v43, v[180:181]
    s_mov_b64 exec, 1
    ds_add_u32 v10, v11 offset:40
    s_mov_b64 exec, -1
    s_mov_b32 s56, 4000000
L_lw41:
    ds_read_b32 v15, v10 offset:40
    s_waitcnt lgkmcnt(0)
    v_readfirstlane_b32 s76, v15
    s_nop 0
    s_cmp_ge_u32 s76, s46
    s_cbranch_scc1 L_lwd41
    s_sub_u32 s56, s56, 1
    s_cbranch_scc0 L_lw41
L_lwd41:
    s_mov_b64 exec, s[70:71]
    ds_read_b128 v[80:83], v46 offset:0
    ds_read_b128 v[96:99], v47 offset:0
    ds_read_b128 v[84:87], v46 offset:16
    ds_read_b128 v[100:103], v47 offset:16
    ds_read_b128 v[88:91], v46 offset:32
    ds_read_b128 v[104:107], v47 offset:32
    ds_read_b128 v[92:95], v46 offset:48
    ds_read_b128 v[108:111], v47 offset:48
    s_mov_b64 exec, -1
    s_waitcnt lgkmcnt(6)
    v_mfma_f32_32x32x16_bf16 v[132:147], v[96:99], v[64:67], 0
    v_mfma_f32_32x32x16_bf16 v[116:131], v[80:83], v[64:67], 0
    s_waitcnt lgkmcnt(4)
    v_mfma_f32_32x32x16_bf16 v[132:147], v[100:103], v[68:71], v[132:147]
    v_mfma_f32_32x32x16_bf16 v[116:131], v[84:87], v[68:71], v[116:131]
    s_waitcnt lgkmcnt(2)
    v_mfma_f32_32x32x16_bf16 v[132:147], v[104:107], v[72:75], v[132:147]
    v_mfma_f32_32x32x16_bf16 v[116:131], v[88:91], v[72:75], v[116:131]
    s_waitcnt lgkmcnt(0)
    v_mfma_f32_32x32x16_bf16 v[132:147], v[108:111], v[76:79], v[132:147]
    v_mfma_f32_32x32x16_bf16 v[116:131], v[92:95], v[76:79], v[116:131]
    s_nop 10
    v_add_f32 v56, 0x358637bd, v132
    v_add_f32 v58, 0x358637bd, v140
    v_rcp_f32 v56, v56
    v_rcp_f32 v58, v58
    v_pk_mul_f32 v[116:117], v[116:117], v[56:57] op_sel_hi:[1,0]
    v_pk_mul_f32 v[118:119], v[118:119], v[56:57] op_sel_hi:[1,0]
    v_pk_mul_f32 v[120:121], v[120:121], v[56:57] op_sel_hi:[1,0]
    v_pk_mul_f32 v[122:123], v[122:123], v[56:57] op_sel_hi:[1,0]
    v_pk_mul_f32 v[124:125], v[124:125], v[58:59] op_sel_hi:[1,0]
    v_pk_mul_f32 v[126:127], v[126:127], v[58:59] op_sel_hi:[1,0]
    v_pk_mul_f32 v[128:129], v[128:129], v[58:59] op_sel_hi:[1,0]
    v_pk_mul_f32 v[130:131], v[130:131], v[58:59] op_sel_hi:[1,0]
    v_cvt_pk_bf16_f32 v148, v116, v117
    v_cvt_pk_bf16_f32 v149, v118, v119
    v_cvt_pk_bf16_f32 v150, v120, v121
    v_cvt_pk_bf16_f32 v151, v122, v123
    v_cvt_pk_bf16_f32 v152, v124, v125
    v_cvt_pk_bf16_f32 v153, v126, v127
    v_cvt_pk_bf16_f32 v154, v128, v129
    v_cvt_pk_bf16_f32 v155, v130, v131
    buffer_store_dwordx4 v[148:151], v252, s[40:43], s58 offen offset:0 sc1
    buffer_store_dwordx4 v[152:155], v252, s[40:43], s58 offen offset:512 sc1
    s_add_u32 s65, s64, s53
    v_mov_b32 v15, s65
    v_lshlrev_b32 v255, 2, v1
    s_waitcnt vmcnt(0)
    s_mov_b32 exec_hi, 0
    buffer_store_dword v15, v255, s[40:43], s62 offen sc1
    s_mov_b32 exec_hi, -1
    s_mov_b32 s56, 4000000
L_lw42:
    ds_read_b32 v15, v10 offset:44
    s_waitcnt lgkmcnt(0)
    v_readfirstlane_b32 s76, v15
    s_nop 0
    s_cmp_ge_u32 s76, s55
    s_cbranch_scc1 L_lwd42
    s_sub_u32 s56, s56, 1
    s_cbranch_scc0 L_lw42
L_lwd42:
    v_subrev_u32 v228, 12288, v247
    v_subrev_u32 v229, 12288, v248
    v_subrev_u32 v230, 12288, v249
    v_subrev_u32 v231, 12288, v250
    ds_read_b64_tr_b16 v[180:181], v228 offset:0
    ds_read_b64_tr_b16 v[182:183], v228 offset:1024
    ds_read_b64_tr_b16 v[184:185], v229 offset:0
    ds_read_b64_tr_b16 v[186:187], v229 offset:1024
    ds_read_b64_tr_b16 v[188:189], v230 offset:0
    ds_read_b64_tr_b16 v[190:191], v230 offset:1024
    ds_read_b64_tr_b16 v[192:193], v231 offset:0
    ds_read_b64_tr_b16 v[194:195], v231 offset:1024
    s_mov_b64 exec, 1
    ds_add_u32 v10, v11 offset:68
    s_mov_b64 exec, -1
    ds_read_b64_tr_b16 v[196:197], v247 offset:0
    ds_read_b64_tr_b16 v[198:199], v247 offset:1024
    ds_read_b64_tr_b16 v[200:201], v248 offset:0
    ds_read_b64_tr_b16 v[202:203], v248 offset:1024
    ds_read_b64_tr_b16 v[204:205], v249 offset:0
    ds_read_b64_tr_b16 v[206:207], v249 offset:1024
    ds_read_b64_tr_b16 v[208:209], v250 offset:0
    ds_read_b64_tr_b16 v[210:211], v250 offset:1024
    s_add_u32 s54, s47, s58
    s_add_u32 s45, s54, 12288
    s_add_u32 s65, s64, s53
    s_mov_b32 s56, 200000
    s_lshl_b64 exec, 1, s81
    s_mov_b32 s76, 0
L_poll_OA:
    buffer_load_dword v15, v245, s[40:43], 0 offen sc1
    s_waitcnt vmcnt(0)
    v_subrev_u32 v15, s65, v15
    v_cmp_le_u32 vcc, 8, v15
    s_nop 1
    s_cbranch_vccnz L_pollmore_OA
    s_cmp_lg_u32 s76, 0
    s_cbranch_scc1 L_polldone_OA
    s_mov_b32 s76, 1
    s_mov_b64 exec, 0xffff
    s_branch L_poll_OA
L_pollmore_OA:
    s_mov_b64 exec, vcc
    s_sub_u32 s56, s56, 1
    s_cbranch_scc0 L_poll_OA
L_polldone_OA:
    s_mov_b64 exec, -1
    buffer_load_dwordx4 v[116:119], v2, s[40:43], s45 offen offset:3072
    buffer_load_dwordx4 v[120:123], v2, s[40:43], s54 offen offset:0
    buffer_load_dwordx4 v[124:127], v2, s[40:43], s54 offen offset:1024
    buffer_load_dwordx4 v[128:131], v2, s[40:43], s54 offen offset:2048
    buffer_load_dwordx4 v[132:135], v2, s[40:43], s54 offen offset:3072
    s_add_u32 s54, s54, 4096
    buffer_load_dwordx4 v[136:139], v2, s[40:43], s54 offen offset:0
    buffer_load_dwordx4 v[140:143], v2, s[40:43], s54 offen offset:1024
    buffer_load_dwordx4 v[144:147], v2, s[40:43], s54 offen offset:2048
    buffer_load_dwordx4 v[148:151], v2, s[40:43], s54 offen offset:3072
    s_add_u32 s54, s54, 4096
    buffer_load_dwordx4 v[152:155], v2, s[40:43], s54 offen offset:0
    buffer_load_dwordx4 v[156:159], v2, s[40:43], s54 offen offset:1024
    buffer_load_dwordx4 v[160:163], v2, s[40:43], s54 offen offset:2048
    buffer_load_dwordx4 v[164:167], v2, s[40:43], s54 offen offset:3072
    s_add_u32 s54, s54, 4096
    buffer_load_dwordx4 v[168:171], v2, s[40:43], s54 offen offset:0
    buffer_load_dwordx4 v[172:175], v2, s[40:43], s54 offen offset:1024
    buffer_load_dwordx4 v[176:179], v2, s[40:43], s54 offen offset:2048
    s_waitcnt vmcnt(15) lgkmcnt(9)
    v_mfma_f32_16x16x32_bf16 v[64:67], v[180:183], v[116:119], 0
    ds_read_b64_tr_b16 v[212:213], v247 offset:4096
    ds_read_b64_tr_b16 v[214:215], v247 offset:5120
    v_mfma_f32_16x16x32_bf16 v[68:71], v[184:187], v[116:119], 0
    ds_read_b64_tr_b16 v[216:217], v248 offset:4096
    ds_read_b64_tr_b16 v[218:219], v248 offset:5120
    v_mfma_f32_16x16x32_bf16 v[72:75], v[188:191], v[116:119], 0
    ds_read_b64_tr_b16 v[220:221], v249 offset:4096
    ds_read_b64_tr_b16 v[222:223], v249 offset:5120
    v_mfma_f32_16x16x32_bf16 v[76:79], v[192:195], v[116:119], 0
    ds_read_b64_tr_b16 v[224:225], v250 offset:4096
    ds_read_b64_tr_b16 v[226:227], v250 offset:5120
    s_waitcnt vmcnt(14) lgkmcnt(8)
    v_mfma_f32_16x16x32_bf16 v[64:67], v[196:199], v[120:123], v[64:67]
    ds_read_b64_tr_b16 v[180:181], v247 offset:8192
    ds_read_b64_tr_b16 v[182:183], v247 offset:9216
    v_mfma_f32_16x16x32_bf16 v[68:71], v[200:203], v[120:123], v[68:71]
    ds_read_b64_tr_b16 v[184:185], v248 offset:8192
    ds_read_b64_tr_b16 v[186:187], v248 offset:9216
    v_mfma_f32_16x16x32_bf16 v[72:75], v[204:207], v[120:123], v[72:75]
    ds_read_b64_tr_b16 v[188:189], v249 offset:8192
    ds_read_b64_tr_b16 v[190:191], v249 offset:9216
    v_mfma_f32_16x16x32_bf16 v[76:79], v[208:211], v[120:123], v[76:79]
    ds_read_b64_tr_b16 v[192:193], v250 offset:8192
    ds_read_b64_tr_b16 v[194:195], v250 offset:9216
    s_waitcnt vmcnt(13) lgkmcnt(8)
    v_mfma_f32_16x16x32_bf16 v[64:67], v[212:215], v[124:127], v[64:67]
    ds_read_b64_tr_b16 v[196:197], v247 offset:12288
    ds_read_b64_tr_b16 v[198:199], v247 offset:13312
    v_mfma_f32_16x16x32_bf16 v[68:71], v[216:219], v[124:127], v[68:71]
    ds_read_b64_tr_b16 v[200:201], v248 offset:12288
    ds_read_b64_tr_b16 v[202:203], v248 offset:13312
    v_mfma_f32_16x16x32_bf16 v[72:75], v[220:223], v[124:127], v[72:75]
    ds_read_b64_tr_b16 v[204:205], v249 offset:12288
    ds_read_b64_tr_b16 v[206:207], v249 offset:13312
    v_mfma_f32_16x16x32_bf16 v[76:79], v[224:227], v[124:127], v[76:79]
    ds_read_b64_tr_b16 v[208:209], v250 offset:12288
    ds_read_b64_tr_b16 v[210:211], v250 offset:13312
    s_waitcnt vmcnt(12) lgkmcnt(8)
    v_mfma_f32_16x16x32_bf16 v[64:67], v[180:183], v[128:131], v[64:67]
    ds_read_b64_tr_b16 v[212:213], v247 offset:16384
    ds_read_b64_tr_b16 v[214:215], v247 offset:17408
    v_mfma_f32_16x16x32_bf16 v[68:71], v[184:187], v[128:131], v[68:71]
    ds_read_b64_tr_b16 v[216:217], v248 offset:16384
    ds_read_b64_tr_b16 v[218:219], v248 offset:17408
    v_mfma_f32_16x16x32_bf16 v[72:75], v[188:191], v[128:131], v[72:75]
    ds_read_b64_tr_b16 v[220:221], v249 offset:16384
    ds_read_b64_tr_b16 v[222:223], v249 offset:17408
    v_mfma_f32_16x16x32_bf16 v[76:79], v[192:195], v[128:131], v[76:79]
    ds_read_b64_tr_b16 v[224:225], v250 offset:16384
    ds_read_b64_tr_b16 v[226:227], v250 offset:17408
    s_waitcnt vmcnt(11) lgkmcnt(8)
    v_mfma_f32_16x16x32_bf16 v[64:67], v[196:199], v[132:135], v[64:67]
    ds_read_b64_tr_b16 v[180:181], v247 offset:20480
    ds_read_b64_tr_b16 v[182:183], v247 offset:21504
    v_mfma_f32_16x16x32_bf16 v[68:71], v[200:203], v[132:135], v[68:71]
    ds_read_b64_tr_b16 v[184:185], v248 offset:20480
    ds_read_b64_tr_b16 v[186:187], v248 offset:21504
    v_mfma_f32_16x16x32_bf16 v[72:75], v[204:207], v[132:135], v[72:75]
    ds_read_b64_tr_b16 v[188:189], v249 offset:20480
    ds_read_b64_tr_b16 v[190:191], v249 offset:21504
    v_mfma_f32_16x16x32_bf16 v[76:79], v[208:211], v[132:135], v[76:79]
    ds_read_b64_tr_b16 v[192:193], v250 offset:20480
    ds_read_b64_tr_b16 v[194:195], v250 offset:21504
    s_waitcnt vmcnt(10) lgkmcnt(8)
    v_mfma_f32_16x16x32_bf16 v[64:67], v[212:215], v[136:139], v[64:67]
    ds_read_b64_tr_b16 v[196:197], v247 offset:24576
    ds_read_b64_tr_b16 v[198:199], v247 offset:25600
    v_mfma_f32_16x16x32_bf16 v[68:71], v[216:219], v[136:139], v[68:71]
    ds_read_b64_tr_b16 v[200:201], v248 offset:24576
    ds_read_b64_tr_b16 v[202:203], v248 offset:25600
    v_mfma_f32_16x16x32_bf16 v[72:75], v[220:223], v[136:139], v[72:75]
    ds_read_b64_tr_b16 v[204:205], v249 offset:24576
    ds_read_b64_tr_b16 v[206:207], v249 offset:25600
    v_mfma_f32_16x16x32_bf16 v[76:79], v[224:227], v[136:139], v[76:79]
    ds_read_b64_tr_b16 v[208:209], v250 offset:24576
    ds_read_b64_tr_b16 v[210:211], v250 offset:25600
    s_waitcnt vmcnt(9) lgkmcnt(8)
    v_mfma_f32_16x16x32_bf16 v[64:67], v[180:183], v[140:143], v[64:67]
    ds_read_b64_tr_b16 v[212:213], v247 offset:28672
    ds_read_b64_tr_b16 v[214:215], v247 offset:29696
    v_mfma_f32_16x16x32_bf16 v[68:71], v[184:187], v[140:143], v[68:71]
    ds_read_b64_tr_b16 v[216:217], v248 offset:28672
    ds_read_b64_tr_b16 v[218:219], v248 offset:29696
    v_mfma_f32_16x16x32_bf16 v[72:75], v[188:191], v[140:143], v[72:75]
    ds_read_b64_tr_b16 v[220:221], v249 offset:28672
    ds_read_b64_tr_b16 v[222:223], v249 offset:29696
    v_mfma_f32_16x16x32_bf16 v[76:79], v[192:195], v[140:143], v[76:79]
    ds_read_b64_tr_b16 v[224:225], v250 offset:28672
    ds_read_b64_tr_b16 v[226:227], v250 offset:29696
    s_waitcnt vmcnt(8) lgkmcnt(8)
    v_mfma_f32_16x16x32_bf16 v[64:67], v[196:199], v[144:147], v[64:67]
    ds_read_b64_tr_b16 v[180:181], v247 offset:32768
    ds_read_b64_tr_b16 v[182:183], v247 offset:33792
    v_mfma_f32_16x16x32_bf16 v[68:71], v[200:203], v[144:147], v[68:71]
    ds_read_b64_tr_b16 v[184:185], v248 offset:32768
    ds_read_b64_tr_b16 v[186:187], v248 offset:33792
    v_mfma_f32_16x16x32_bf16 v[72:75], v[204:207], v[144:147], v[72:75]
    ds_read_b64_tr_b16 v[188:189], v249 offset:32768
    ds_read_b64_tr_b16 v[190:191], v249 offset:33792
    v_mfma_f32_16x16x32_bf16 v[76:79], v[208:211], v[144:147], v[76:79]
    ds_read_b64_tr_b16 v[192:193], v250 offset:32768
    ds_read_b64_tr_b16 v[194:195], v250 offset:33792
    s_waitcnt vmcnt(7) lgkmcnt(8)
    v_mfma_f32_16x16x32_bf16 v[64:67], v[212:215], v[148:151], v[64:67]
    ds_read_b64_tr_b16 v[196:197], v247 offset:36864
    ds_read_b64_tr_b16 v[198:199], v247 offset:37888
    v_mfma_f32_16x16x32_bf16 v[68:71], v[216:219], v[148:151], v[68:71]
    ds_read_b64_tr_b16 v[200:201], v248 offset:36864
    ds_read_b64_tr_b16 v[202:203], v248 offset:37888
    v_mfma_f32_16x16x32_bf16 v[72:75], v[220:223], v[148:151], v[72:75]
    ds_read_b64_tr_b16 v[204:205], v249 offset:36864
    ds_read_b64_tr_b16 v[206:207], v249 offset:37888
    v_mfma_f32_16x16x32_bf16 v[76:79], v[224:227], v[148:151], v[76:79]
    ds_read_b64_tr_b16 v[208:209], v250 offset:36864
    ds_read_b64_tr_b16 v[210:211], v250 offset:37888
    s_waitcnt vmcnt(6) lgkmcnt(8)
    v_mfma_f32_16x16x32_bf16 v[64:67], v[180:183], v[152:155], v[64:67]
    ds_read_b64_tr_b16 v[212:213], v247 offset:40960
    ds_read_b64_tr_b16 v[214:215], v247 offset:41984
    v_mfma_f32_16x16x32_bf16 v[68:71], v[184:187], v[152:155], v[68:71]
    ds_read_b64_tr_b16 v[216:217], v248 offset:40960
    ds_read_b64_tr_b16 v[218:219], v248 offset:41984
    v_mfma_f32_16x16x32_bf16 v[72:75], v[188:191], v[152:155], v[72:75]
    ds_read_b64_tr_b16 v[220:221], v249 offset:40960
    ds_read_b64_tr_b16 v[222:223], v249 offset:41984
    v_mfma_f32_16x16x32_bf16 v[76:79], v[192:195], v[152:155], v[76:79]
    ds_read_b64_tr_b16 v[224:225], v250 offset:40960
    ds_read_b64_tr_b16 v[226:227], v250 offset:41984
    s_waitcnt vmcnt(5) lgkmcnt(8)
    v_mfma_f32_16x16x32_bf16 v[64:67], v[196:199], v[156:159], v[64:67]
    ds_read_b64_tr_b16 v[180:181], v247 offset:45056
    ds_read_b64_tr_b16 v[182:183], v247 offset:46080
    v_mfma_f32_16x16x32_bf16 v[68:71], v[200:203], v[156:159], v[68:71]
    ds_read_b64_tr_b16 v[184:185], v248 offset:45056
    ds_read_b64_tr_b16 v[186:187], v248 offset:46080
    v_mfma_f32_16x16x32_bf16 v[72:75], v[204:207], v[156:159], v[72:75]
    ds_read_b64_tr_b16 v[188:189], v249 offset:45056
    ds_read_b64_tr_b16 v[190:191], v249 offset:46080
    v_mfma_f32_16x16x32_bf16 v[76:79], v[208:211], v[156:159], v[76:79]
    ds_read_b64_tr_b16 v[192:193], v250 offset:45056
    ds_read_b64_tr_b16 v[194:195], v250 offset:46080
    s_waitcnt vmcnt(4) lgkmcnt(8)
    v_mfma_f32_16x16x32_bf16 v[64:67], v[212:215], v[160:163], v[64:67]
    ds_read_b64_tr_b16 v[196:197], v247 offset:49152
    ds_read_b64_tr_b16 v[198:199], v247 offset:50176
    v_mfma_f32_16x16x32_bf16 v[68:71], v[216:219], v[160:163], v[68:71]
    ds_read_b64_tr_b16 v[200:201], v248 offset:49152
    ds_read_b64_tr_b16 v[202:203], v248 offset:50176
    v_mfma_f32_16x16x32_bf16 v[72:75], v[220:223], v[160:163], v[72:75]
    ds_read_b64_tr_b16 v[204:205], v249 offset:49152
    ds_read_b64_tr_b16 v[206:207], v249 offset:50176
    v_mfma_f32_16x16x32_bf16 v[76:79], v[224:227], v[160:163], v[76:79]
    ds_read_b64_tr_b16 v[208:209], v250 offset:49152
    ds_read_b64_tr_b16 v[210:211], v250 offset:50176
    s_waitcnt vmcnt(3) lgkmcnt(8)
    v_mfma_f32_16x16x32_bf16 v[64:67], v[180:183], v[164:167], v[64:67]
    ds_read_b64_tr_b16 v[212:213], v247 offset:53248
    ds_read_b64_tr_b16 v[214:215], v247 offset:54272
    v_mfma_f32_16x16x32_bf16 v[68:71], v[184:187], v[164:167], v[68:71]
    ds_read_b64_tr_b16 v[216:217], v248 offset:53248
    ds_read_b64_tr_b16 v[218:219], v248 offset:54272
    v_mfma_f32_16x16x32_bf16 v[72:75], v[188:191], v[164:167], v[72:75]
    ds_read_b64_tr_b16 v[220:221], v249 offset:53248
    ds_read_b64_tr_b16 v[222:223], v249 offset:54272
    v_mfma_f32_16x16x32_bf16 v[76:79], v[192:195], v[164:167], v[76:79]
    ds_read_b64_tr_b16 v[224:225], v250 offset:53248
    ds_read_b64_tr_b16 v[226:227], v250 offset:54272
    s_waitcnt vmcnt(2) lgkmcnt(8)
    v_mfma_f32_16x16x32_bf16 v[64:67], v[196:199], v[168:171], v[64:67]
    ds_read_b64_tr_b16 v[180:181], v247 offset:57344
    ds_read_b64_tr_b16 v[182:183], v247 offset:58368
    v_mfma_f32_16x16x32_bf16 v[68:71], v[200:203], v[168:171], v[68:71]
    ds_read_b64_tr_b16 v[184:185], v248 offset:57344
    ds_read_b64_tr_b16 v[186:187], v248 offset:58368
    v_mfma_f32_16x16x32_bf16 v[72:75], v[204:207], v[168:171], v[72:75]
    ds_read_b64_tr_b16 v[188:189], v249 offset:57344
    ds_read_b64_tr_b16 v[190:191], v249 offset:58368
    v_mfma_f32_16x16x32_bf16 v[76:79], v[208:211], v[168:171], v[76:79]
    ds_read_b64_tr_b16 v[192:193], v250 offset:57344
    ds_read_b64_tr_b16 v[194:195], v250 offset:58368
    s_waitcnt vmcnt(1) lgkmcnt(8)
    v_mfma_f32_16x16x32_bf16 v[64:67], v[212:215], v[172:175], v[64:67]
    v_mfma_f32_16x16x32_bf16 v[68:71], v[216:219], v[172:175], v[68:71]
    v_mfma_f32_16x16x32_bf16 v[72:75], v[220:223], v[172:175], v[72:75]
    v_mfma_f32_16x16x32_bf16 v[76:79], v[224:227], v[172:175], v[76:79]
    s_waitcnt vmcnt(0) lgkmcnt(0)
    v_mfma_f32_16x16x32_bf16 v[64:67], v[180:183], v[176:179], v[64:67]
    v_mfma_f32_16x16x32_bf16 v[68:71], v[184:187], v[176:179], v[68:71]
    v_mfma_f32_16x16x32_bf16 v[72:75], v[188:191], v[176:179], v[72:75]
    v_mfma_f32_16x16x32_bf16 v[76:79], v[192:195], v[176:179], v[76:79]
    s_nop 4
    v_pk_add_f32 v[64:65], v[64:65], v[16:17]
    v_pk_add_f32 v[66:67], v[66:67], v[18:19]
    v_pk_add_f32 v[68:69], v[68:69], v[20:21]
    v_pk_add_f32 v[70:71], v[70:71], v[22:23]
    v_pk_add_f32 v[72:73], v[72:73], v[24:25]
    v_pk_add_f32 v[74:75], v[74:75], v[26:27]
    v_pk_add_f32 v[76:77], v[76:77], v[28:29]
    v_pk_add_f32 v[78:79], v[78:79], v[30:31]
    v_cvt_pk_bf16_f32 v80, v64, v65
    v_cvt_pk_bf16_f32 v81, v66, v67
    v_cvt_pk_bf16_f32 v82, v68, v69
    v_cvt_pk_bf16_f32 v83, v70, v71
    v_cvt_pk_bf16_f32 v84, v72, v73
    v_cvt_pk_bf16_f32 v85, v74, v75
    v_cvt_pk_bf16_f32 v86, v76, v77
    v_cvt_pk_bf16_f32 v87, v78, v79
    buffer_store_dwordx4 v[80:83], v251, s[40:43], s59 offen offset:0 sc1
    buffer_store_dwordx4 v[84:87], v251, s[40:43], s59 offen offset:2048 sc1
    v_lshlrev_b32 v16, 16, v80
    v_and_b32 v17, 0xffff0000, v80
    v_lshlrev_b32 v18, 16, v81
    v_and_b32 v19, 0xffff0000, v81
    v_lshlrev_b32 v20, 16, v82
    v_and_b32 v21, 0xffff0000, v82
    v_lshlrev_b32 v22, 16, v83
    v_and_b32 v23, 0xffff0000, v83
    v_lshlrev_b32 v24, 16, v84
    v_and_b32 v25, 0xffff0000, v84
    v_lshlrev_b32 v26, 16, v85
    v_and_b32 v27, 0xffff0000, v85
    v_lshlrev_b32 v28, 16, v86
    v_and_b32 v29, 0xffff0000, v86
    v_lshlrev_b32 v30, 16, v87
    v_and_b32 v31, 0xffff0000, v87
    v_pk_add_f32 v[116:117], v[16:17], v[18:19]
    v_pk_add_f32 v[118:119], v[20:21], v[22:23]
    v_pk_add_f32 v[120:121], v[24:25], v[26:27]
    v_pk_add_f32 v[122:123], v[28:29], v[30:31]
    v_pk_mul_f32 v[124:125], v[16:17], v[16:17]
    v_pk_mul_f32 v[126:127], v[18:19], v[18:19]
    v_pk_add_f32 v[116:117], v[116:117], v[118:119]
    v_pk_add_f32 v[120:121], v[120:121], v[122:123]
    v_pk_fma_f32 v[124:125], v[20:21], v[20:21], v[124:125]
    v_pk_fma_f32 v[126:127], v[22:23], v[22:23], v[126:127]
    v_pk_fma_f32 v[124:125], v[24:25], v[24:25], v[124:125]
    v_pk_fma_f32 v[126:127], v[26:27], v[26:27], v[126:127]
    v_pk_fma_f32 v[124:125], v[28:29], v[28:29], v[124:125]
    v_pk_fma_f32 v[126:127], v[30:31], v[30:31], v[126:127]
    v_pk_add_f32 v[116:117], v[116:117], v[120:121]
    v_pk_add_f32 v[124:125], v[124:125], v[126:127]
    v_add_f32 v116, v116, v117
    v_add_f32 v124, v124, v125
    s_nop 1
    v_permlane32_swap_b32 v116, v124
    v_add_f32 v116, v116, v124
    v_mov_b32 v124, v116
    s_nop 1
    v_permlane16_swap_b32 v116, v124
    v_add_f32 v116, v116, v124
    s_mov_b32 s100, 0xffff
    s_mov_b32 s101, 0xffff
    s_mov_b64 exec, s[100:101]
    buffer_store_dword v116, v12, s[40:43], s44 offen sc1
    s_mov_b64 exec, -1
    s_add_u32 s65, s64, s53
    v_mov_b32 v15, s65
    v_lshlrev_b32 v255, 2, v1
    s_waitcnt vmcnt(0)
    s_mov_b32 exec_hi, 0
    buffer_store_dword v15, v255, s[40:43], s61 offen sc1
    s_mov_b32 exec_hi, -1
    s_add_u32 s57, s57, 131072
    s_add_u32 s59, s59, 131072
    s_add_u32 s58, s58, 131072
    s_add_u32 s44, s44, 8192
    s_add_u32 s65, s64, s53
    s_mov_b32 s56, 200000
    s_lshl_b64 exec, 1, s80
    s_mov_b32 s76, 0
L_poll_XB:
    buffer_load_dword v15, v244, s[40:43], 0 offen sc1
    s_waitcnt vmcnt(0)
    v_subrev_u32 v15, s65, v15
    v_cmp_le_u32 vcc, 8, v15
    s_nop 1
    s_cbranch_vccnz L_pollmore_XB
    s_cmp_lg_u32 s76, 0
    s_cbranch_scc1 L_polldone_XB
    s_mov_b32 s76, 1
    s_mov_b64 exec, 0xffff
    s_branch L_poll_XB
L_pollmore_XB:
    s_mov_b64 exec, vcc
    s_sub_u32 s56, s56, 1
    s_cbranch_scc0 L_poll_XB
L_polldone_XB:
    s_mov_b64 exec, -1
    s_add_u32 s53, s53, 1
    s_add_u32 s55, s55, 4
    s_mov_b64 exec, 1
    ds_add_u32 v10, v11 offset:48
    s_mov_b64 exec, -1
    s_mov_b32 s54, s57
    buffer_load_dwordx4 v[116:119], v2, s[40:43], s54 offen offset:0
    buffer_load_dwordx4 v[120:123], v2, s[40:43], s54 offen offset:1024
    buffer_load_dwordx4 v[124:127], v2, s[40:43], s54 offen offset:2048
    buffer_load_dwordx4 v[128:131], v2, s[40:43], s54 offen offset:3072
    s_add_u32 s54, s54, 4096
    buffer_load_dwordx4 v[132:135], v2, s[40:43], s54 offen offset:0
    buffer_load_dwordx4 v[136:139], v2, s[40:43], s54 offen offset:1024
    buffer_load_dwordx4 v[140:143], v2, s[40:43], s54 offen offset:2048
    buffer_load_dwordx4 v[144:147], v2, s[40:43], s54 offen offset:3072
    v_and_b32 v255, 7, v1
    v_lshl_add_u32 v255, v255, 2, v10
    ds_read_b32 v255, v255
    s_add_u32 s54, s54, 4096
    buffer_load_dwordx4 v[148:151], v2, s[40:43], s54 offen offset:0
    buffer_load_dwordx4 v[152:155], v2, s[40:43], s54 offen offset:1024
    s_waitcnt lgkmcnt(0)
    v_cmp_gt_u32 vcc, s55, v255
    s_nop 1
    s_cmp_eq_u64 vcc, 0
    s_cselect_b32 s67, 1, 0
    s_cmp_lg_u32 s67, 0
    s_cbranch_scc1 L_cc43
    s_mov_b32 s56, 4000000
L_lw44:
    ds_read_b32 v255, v10 offset:0
    s_waitcnt lgkmcnt(0)
    v_readfirstlane_b32 s76, v255
    s_nop 0
    s_cmp_ge_u32 s76, s55
    s_cbranch_scc1 L_lwd44
    s_sub_u32 s56, s56, 1
    s_cbranch_scc0 L_lw44
L_lwd44:
L_cc43:
    ds_read_b64_tr_b16 v[40:41], v3 offset:0
    ds_read_b64_tr_b16 v[42:43], v4 offset:0
    ds_read_b64_tr_b16 v[44:45], v3 offset:4096
    ds_read_b64_tr_b16 v[46:47], v4 offset:4096
    ds_read_b64_tr_b16 v[48:49], v3 offset:8192
    ds_read_b64_tr_b16 v[50:51], v4 offset:8192
    s_waitcnt vmcnt(9) lgkmcnt(4)
    v_mfma_f32_32x32x16_bf16 v[64:79], v[40:43], v[116:119], 0
    ds_read_b64_tr_b16 v[52:53], v5 offset:0
    ds_read_b64_tr_b16 v[54:55], v6 offset:0
    buffer_load_dwordx4 v[156:159], v2, s[40:43], s54 offen offset:2048
    s_waitcnt lgkmcnt(4)
    v_mfma_f32_32x32x16_bf16 v[80:95], v[44:47], v[116:119], 0
    ds_read_b64_tr_b16 v[56:57], v5 offset:4096
    ds_read_b64_tr_b16 v[58:59], v6 offset:4096
    buffer_load_dwordx4 v[160:163], v2, s[40:43], s54 offen offset:3072
    s_waitcnt lgkmcnt(4)
    v_mfma_f32_32x32x16_bf16 v[96:111], v[48:51], v[116:119], 0
    ds_read_b64_tr_b16 v[60:61], v5 offset:8192
    ds_read_b64_tr_b16 v[62:63], v6 offset:8192
    s_waitcnt vmcnt(10) lgkmcnt(4)
    v_mfma_f32_32x32x16_bf16 v[64:79], v[52:55], v[120:123], v[64:79]
    ds_read_b64_tr_b16 v[40:41], v3 offset:2048
    ds_read_b64_tr_b16 v[42:43], v4 offset:2048
    s_add_u32 s54, s54, 4096
    buffer_load_dwordx4 v[164:167], v2, s[40:43], s54 offen offset:0
    s_waitcnt lgkmcnt(4)
    v_mfma_f32_32x32x16_bf16 v[80:95], v[56:59], v[120:123], v[80:95]
    ds_read_b64_tr_b16 v[44:45], v3 offset:6144
    ds_read_b64_tr_b16 v[46:47], v4 offset:6144
    buffer_load_dwordx4 v[168:171], v2, s[40:43], s54 offen offset:1024
    s_waitcnt lgkmcnt(4)
    v_mfma_f32_32x32x16_bf16 v[96:111], v[60:63], v[120:123], v[96:111]
    ds_read_b64_tr_b16 v[48:49], v3 offset:10240
    ds_read_b64_tr_b16 v[50:51], v4 offset:10240
    s_waitcnt vmcnt(11) lgkmcnt(4)
    v_mfma_f32_32x32x16_bf16 v[64:79], v[40:43], v[124:127], v[64:79]
    ds_read_b64_tr_b16 v[52:53], v5 offset:2048
    ds_read_b64_tr_b16 v[54:55], v6 offset:2048
    buffer_load_dwordx4 v[172:175], v2, s[40:43], s54 offen offset:2048
    s_waitcnt lgkmcnt(4)
    v_mfma_f32_32x32x16_bf16 v[80:95], v[44:47], v[124:127], v[80:95]
    ds_read_b64_tr_b16 v[56:57], v5 offset:6144
    ds_read_b64_tr_b16 v[58:59], v6 offset:6144
    buffer_load_dwordx4 v[176:179], v2, s[40:43], s54 offen offset:3072
    s_waitcnt lgkmcnt(4)
    v_mfma_f32_32x32x16_bf16 v[96:111], v[48:51], v[124:127], v[96:111]
    ds_read_b64_tr_b16 v[60:61], v5 offset:10240
    ds_read_b64_tr_b16 v[62:63], v6 offset:10240
    s_cmp_lg_u32 s67, 0
    s_cbranch_scc1 L_cc45
    s_mov_b32 s56, 4000000
L_lw46:
    ds_read_b32 v255, v10 offset:4
    s_waitcnt lgkmcnt(0)
    v_readfirstlane_b32 s76, v255
    s_nop 0
    s_cmp_ge_u32 s76, s55
    s_cbranch_scc1 L_lwd46
    s_sub_u32 s56, s56, 1
    s_cbranch_scc0 L_lw46
L_lwd46:
L_cc45:
    s_waitcnt vmcnt(12) lgkmcnt(4)
    v_mfma_f32_32x32x16_bf16 v[64:79], v[52:55], v[128:131], v[64:79]
    ds_read_b64_tr_b16 v[40:41], v3 offset:12288
    ds_read_b64_tr_b16 v[42:43], v4 offset:12288
    s_add_u32 s54, s54, 4096
    buffer_load_dwordx4 v[180:183], v2, s[40:43], s54 offen offset:0
    s_waitcnt lgkmcnt(4)
    v_mfma_f32_32x32x16_bf16 v[80:95], v[56:59], v[128:131], v[80:95]
    ds_read_b64_tr_b16 v[44:45], v3 offset:16384
    ds_read_b64_tr_b16 v[46:47], v4 offset:16384
    buffer_load_dwordx4 v[184:187], v2, s[40:43], s54 offen offset:1024
    s_waitcnt lgkmcnt(4)
    v_mfma_f32_32x32x16_bf16 v[96:111], v[60:63], v[128:131], v[96:111]
    ds_read_b64_tr_b16 v[48:49], v3 offset:20480
    ds_read_b64_tr_b16 v[50:51], v4 offset:20480
    s_waitcnt vmcnt(13) lgkmcnt(4)
    v_mfma_f32_32x32x16_bf16 v[64:79], v[40:43], v[132:135], v[64:79]
    ds_read_b64_tr_b16 v[52:53], v5 offset:12288
    ds_read_b64_tr_b16 v[54:55], v6 offset:12288
    buffer_load_dwordx4 v[188:191], v2, s[40:43], s54 offen offset:2048
    s_waitcnt lgkmcnt(4)
    v_mfma_f32_32x32x16_bf16 v[80:95], v[44:47], v[132:135], v[80:95]
    ds_read_b64_tr_b16 v[56:57], v5 offset:16384
    ds_read_b64_tr_b16 v[58:59], v6 offset:16384
    buffer_load_dwordx4 v[192:195], v2, s[40:43], s54 offen offset:3072
    s_waitcnt lgkmcnt(4)
    v_mfma_f32_32x32x16_bf16 v[96:111], v[48:51], v[132:135], v[96:111]
    ds_read_b64_tr_b16 v[60:61], v5 offset:20480
    ds_read_b64_tr_b16 v[62:63], v6 offset:20480
    s_waitcnt vmcnt(14) lgkmcnt(4)
    v_mfma_f32_32x32x16_bf16 v[64:79], v[52:55], v[136:139], v[64:79]
    ds_read_b64_tr_b16 v[40:41], v3 offset:14336
    ds_read_b64_tr_b16 v[42:43], v4 offset:14336
    s_add_u32 s54, s54, 4096
    buffer_load_dwordx4 v[196:199], v2, s[40:43], s54 offen offset:0
    s_waitcnt lgkmcnt(4)
    v_mfma_f32_32x32x16_bf16 v[80:95], v[56:59], v[136:139], v[80:95]
    ds_read_b64_tr_b16 v[44:45], v3 offset:18432
    ds_read_b64_tr_b16 v[46:47], v4 offset:18432
    buffer_load_dwordx4 v[200:203], v2, s[40:43], s54 offen offset:1024
    s_waitcnt lgkmcnt(4)
    v_mfma_f32_32x32x16_bf16 v[96:111], v[60:63], v[136:139], v[96:111]
    ds_read_b64_tr_b16 v[48:49], v3 offset:22528
    ds_read_b64_tr_b16 v[50:51], v4 offset:22528
    s_waitcnt vmcnt(15) lgkmcnt(4)
    v_mfma_f32_32x32x16_bf16 v[64:79], v[40:43], v[140:143], v[64:79]
    ds_read_b64_tr_b16 v[52:53], v5 offset:14336
    ds_read_b64_tr_b16 v[54:55], v6 offset:14336
    buffer_load_dwordx4 v[204:207], v2, s[40:43], s54 offen offset:2048
    s_waitcnt lgkmcnt(4)
    v_mfma_f32_32x32x16_bf16 v[80:95], v[44:47], v[140:143], v[80:95]
    ds_read_b64_tr_b16 v[56:57], v5 offset:18432
    ds_read_b64_tr_b16 v[58:59], v6 offset:18432
    buffer_load_dwordx4 v[208:211], v2, s[40:43], s54 offen offset:3072
    s_waitcnt lgkmcnt(4)
    v_mfma_f32_32x32x16_bf16 v[96:111], v[48:51], v[140:143], v[96:111]
    ds_read_b64_tr_b16 v[60:61], v5 offset:22528
    ds_read_b64_tr_b16 v[62:63], v6 offset:22528
    s_cmp_lg_u32 s67, 0
    s_cbranch_scc1 L_cc47
    s_mov_b32 s56, 4000000
L_lw48:
    ds_read_b32 v255, v10 offset:8
    s_waitcnt lgkmcnt(0)
    v_readfirstlane_b32 s76, v255
    s_nop 0
    s_cmp_ge_u32 s76, s55
    s_cbranch_scc1 L_lwd48
    s_sub_u32 s56, s56, 1
    s_cbranch_scc0 L_lw48
L_lwd48:
L_cc47:
    s_waitcnt vmcnt(16) lgkmcnt(4)
    v_mfma_f32_32x32x16_bf16 v[64:79], v[52:55], v[144:147], v[64:79]
    ds_read_b64_tr_b16 v[40:41], v3 offset:24576
    ds_read_b64_tr_b16 v[42:43], v4 offset:24576
    s_add_u32 s54, s54, 4096
    buffer_load_dwordx4 v[212:215], v2, s[40:43], s54 offen offset:0
    s_waitcnt lgkmcnt(4)
    v_mfma_f32_32x32x16_bf16 v[80:95], v[56:59], v[144:147], v[80:95]
    ds_read_b64_tr_b16 v[44:45], v3 offset:28672
    ds_read_b64_tr_b16 v[46:47], v4 offset:28672
    buffer_load_dwordx4 v[216:219], v2, s[40:43], s54 offen offset:1024
    s_waitcnt lgkmcnt(4)
    v_mfma_f32_32x32x16_bf16 v[96:111], v[60:63], v[144:147], v[96:111]
    ds_read_b64_tr_b16 v[48:49], v3 offset:32768
    ds_read_b64_tr_b16 v[50:51], v4 offset:32768
    s_waitcnt vmcnt(17) lgkmcnt(4)
    v_mfma_f32_32x32x16_bf16 v[64:79], v[40:43], v[148:151], v[64:79]
    ds_read_b64_tr_b16 v[52:53], v5 offset:24576
    ds_read_b64_tr_b16 v[54:55], v6 offset:24576
    buffer_load_dwordx4 v[220:223], v2, s[40:43], s54 offen offset:2048
    s_waitcnt lgkmcnt(4)
    v_mfma_f32_32x32x16_bf16 v[80:95], v[44:47], v[148:151], v[80:95]
    ds_read_b64_tr_b16 v[56:57], v5 offset:28672
    ds_read_b64_tr_b16 v[58:59], v6 offset:28672
    buffer_load_dwordx4 v[224:227], v2, s[40:43], s54 offen offset:3072
    s_waitcnt lgkmcnt(4)
    v_mfma_f32_32x32x16_bf16 v[96:111], v[48:51], v[148:151], v[96:111]
    ds_read_b64_tr_b16 v[60:61], v5 offset:32768
    ds_read_b64_tr_b16 v[62:63], v6 offset:32768
    s_waitcnt vmcnt(18) lgkmcnt(4)
    v_mfma_f32_32x32x16_bf16 v[64:79], v[52:55], v[152:155], v[64:79]
    ds_read_b64_tr_b16 v[40:41], v3 offset:26624
    ds_read_b64_tr_b16 v[42:43], v4 offset:26624
    s_add_u32 s54, s54, 4096
    buffer_load_dwordx4 v[228:231], v2, s[40:43], s54 offen offset:0
    s_waitcnt lgkmcnt(4)
    v_mfma_f32_32x32x16_bf16 v[80:95], v[56:59], v[152:155], v[80:95]
    ds_read_b64_tr_b16 v[44:45], v3 offset:30720
    ds_read_b64_tr_b16 v[46:47], v4 offset:30720
    buffer_load_dwordx4 v[232:235], v2, s[40:43], s54 offen offset:1024
    s_waitcnt lgkmcnt(4)
    v_mfma_f32_32x32x16_bf16 v[96:111], v[60:63], v[152:155], v[96:111]
    ds_read_b64_tr_b16 v[48:49], v3 offset:34816
    ds_read_b64_tr_b16 v[50:51], v4 offset:34816
    s_waitcnt vmcnt(19) lgkmcnt(4)
    v_mfma_f32_32x32x16_bf16 v[64:79], v[40:43], v[156:159], v[64:79]
    ds_read_b64_tr_b16 v[52:53], v5 offset:26624
    ds_read_b64_tr_b16 v[54:55], v6 offset:26624
    buffer_load_dwordx4 v[236:239], v2, s[40:43], s54 offen offset:2048
    s_waitcnt lgkmcnt(4)
    v_mfma_f32_32x32x16_bf16 v[80:95], v[44:47], v[156:159], v[80:95]
    ds_read_b64_tr_b16 v[56:57], v5 offset:30720
    ds_read_b64_tr_b16 v[58:59], v6 offset:30720
    buffer_load_dwordx4 v[240:243], v2, s[40:43], s54 offen offset:3072
    s_waitcnt lgkmcnt(4)
    v_mfma_f32_32x32x16_bf16 v[96:111], v[48:51], v[156:159], v[96:111]
    ds_read_b64_tr_b16 v[60:61], v5 offset:34816
    ds_read_b64_tr_b16 v[62:63], v6 offset:34816
    ds_read_b32 v15, v10 offset:72
    s_cmp_lg_u32 s67, 0
    s_cbranch_scc1 L_cc49
    s_mov_b32 s56, 4000000
L_lw50:
    ds_read_b32 v255, v10 offset:12
    s_waitcnt lgkmcnt(0)
    v_readfirstlane_b32 s76, v255
    s_nop 0
    s_cmp_ge_u32 s76, s55
    s_cbranch_scc1 L_lwd50
    s_sub_u32 s56, s56, 1
    s_cbranch_scc0 L_lw50
L_lwd50:
L_cc49:
    s_waitcnt vmcnt(20) lgkmcnt(5)
    v_mfma_f32_32x32x16_bf16 v[64:79], v[52:55], v[160:163], v[64:79]
    ds_read_b64_tr_b16 v[40:41], v3 offset:36864
    ds_read_b64_tr_b16 v[42:43], v4 offset:36864
    s_waitcnt lgkmcnt(5)
    v_mfma_f32_32x32x16_bf16 v[80:95], v[56:59], v[160:163], v[80:95]
    ds_read_b64_tr_b16 v[44:45], v3 offset:40960
    ds_read_b64_tr_b16 v[46:47], v4 offset:40960
    s_waitcnt lgkmcnt(5)
    v_mfma_f32_32x32x16_bf16 v[96:111], v[60:63], v[160:163], v[96:111]
    ds_read_b64_tr_b16 v[48:49], v3 offset:45056
    ds_read_b64_tr_b16 v[50:51], v4 offset:45056
    s_waitcnt lgkmcnt(6)
    v_readfirstlane_b32 s76, v15
    s_nop 0
    s_cmp_ge_u32 s76, s53
    s_cbranch_scc1 L_ok51
    s_mov_b32 s56, 4000000
L_lw52:
    ds_read_b32 v15, v10 offset:72
    s_waitcnt lgkmcnt(0)
    v_readfirstlane_b32 s76, v15
    s_nop 0
    s_cmp_ge_u32 s76, s53
    s_cbranch_scc1 L_lwd52
    s_sub_u32 s56, s56, 1
    s_cbranch_scc0 L_lw52
L_lwd52:
L_ok51:
    s_waitcnt vmcnt(19) lgkmcnt(4)
    v_mfma_f32_32x32x16_bf16 v[64:79], v[40:43], v[164:167], v[64:79]
    ds_read_b64_tr_b16 v[52:53], v5 offset:36864
    ds_read_b64_tr_b16 v[54:55], v6 offset:36864
    s_add_u32 s45, s77, s59
    s_sub_u32 s45, s45, 131072
    buffer_load_dwordx4 v[116:119], v7, s[40:43], s45 offen offset:0
    s_waitcnt lgkmcnt(4)
    v_mfma_f32_32x32x16_bf16 v[80:95], v[44:47], v[164:167], v[80:95]
    ds_read_b64_tr_b16 v[56:57], v5 offset:40960
    ds_read_b64_tr_b16 v[58:59], v6 offset:40960
    buffer_load_dwordx4 v[120:123], v7, s[40:43], s45 offen offset:2048
    s_waitcnt lgkmcnt(4)
    v_mfma_f32_32x32x16_bf16 v[96:111], v[48:51], v[164:167], v[96:111]
    ds_read_b64_tr_b16 v[60:61], v5 offset:45056
    ds_read_b64_tr_b16 v[62:63], v6 offset:45056
    s_mov_b64 exec, 1
    ds_add_u32 v10, v11 offset:64
    s_mov_b64 exec, -1
    s_waitcnt vmcnt(20) lgkmcnt(5)
    v_mfma_f32_32x32x16_bf16 v[64:79], v[52:55], v[168:171], v[64:79]
    ds_read_b64_tr_b16 v[40:41], v3 offset:38912
    ds_read_b64_tr_b16 v[42:43], v4 offset:38912
    s_add_u32 s45, s45, 4096
    buffer_load_dwordx4 v[124:127], v7, s[40:43], s45 offen offset:0
    s_waitcnt lgkmcnt(5)
    v_mfma_f32_32x32x16_bf16 v[80:95], v[56:59], v[168:171], v[80:95]
    ds_read_b64_tr_b16 v[44:45], v3 offset:43008
    ds_read_b64_tr_b16 v[46:47], v4 offset:43008
    buffer_load_dwordx4 v[128:131], v7, s[40:43], s45 offen offset:2048
    s_waitcnt lgkmcnt(5)
    v_mfma_f32_32x32x16_bf16 v[96:111], v[60:63], v[168:171], v[96:111]
    ds_read_b64_tr_b16 v[48:49], v3 offset:47104
    ds_read_b64_tr_b16 v[50:51], v4 offset:47104
    s_waitcnt vmcnt(21) lgkmcnt(4)
    v_mfma_f32_32x32x16_bf16 v[64:79], v[40:43], v[172:175], v[64:79]
    ds_read_b64_tr_b16 v[52:53], v5 offset:38912
    ds_read_b64_tr_b16 v[54:55], v6 offset:38912
    s_add_u32 s45, s45, 4096
    buffer_load_dwordx4 v[132:135], v7, s[40:43], s45 offen offset:0
    s_waitcnt lgkmcnt(4)
    v_mfma_f32_32x32x16_bf16 v[80:95], v[44:47], v[172:175], v[80:95]
    ds_read_b64_tr_b16 v[56:57], v5 offset:43008
    ds_read_b64_tr_b16 v[58:59], v6 offset:43008
    buffer_load_dwordx4 v[136:139], v7, s[40:43], s45 offen offset:2048
    s_waitcnt lgkmcnt(4)
    v_mfma_f32_32x32x16_bf16 v[96:111], v[48:51], v[172:175], v[96:111]
    ds_read_b64_tr_b16 v[60:61], v5 offset:47104
    ds_read_b64_tr_b16 v[62:63], v6 offset:47104
    s_cmp_lg_u32 s67, 0
    s_cbranch_scc1 L_cc53
    s_mov_b32 s56, 4000000
L_lw54:
    ds_read_b32 v255, v10 offset:16
    s_waitcnt lgkmcnt(0)
    v_readfirstlane_b32 s76, v255
    s_nop 0
    s_cmp_ge_u32 s76, s55
    s_cbranch_scc1 L_lwd54
    s_sub_u32 s56, s56, 1
    s_cbranch_scc0 L_lw54
L_lwd54:
L_cc53:
    s_waitcnt vmcnt(22) lgkmcnt(4)
    v_mfma_f32_32x32x16_bf16 v[64:79], v[52:55], v[176:179], v[64:79]
    ds_read_b64_tr_b16 v[40:41], v3 offset:49152
    ds_read_b64_tr_b16 v[42:43], v4 offset:49152
    s_add_u32 s45, s45, 4096
    buffer_load_dwordx4 v[140:143], v7, s[40:43], s45 offen offset:0
    s_waitcnt lgkmcnt(4)
    v_mfma_f32_32x32x16_bf16 v[80:95], v[56:59], v[176:179], v[80:95]
    ds_read_b64_tr_b16 v[44:45], v3 offset:53248
    ds_read_b64_tr_b16 v[46:47], v4 offset:53248
    buffer_load_dwordx4 v[144:147], v7, s[40:43], s45 offen offset:2048
    s_waitcnt lgkmcnt(4)
    v_mfma_f32_32x32x16_bf16 v[96:111], v[60:63], v[176:179], v[96:111]
    ds_read_b64_tr_b16 v[48:49], v3 offset:57344
    ds_read_b64_tr_b16 v[50:51], v4 offset:57344
    s_waitcnt vmcnt(23) lgkmcnt(4)
    v_mfma_f32_32x32x16_bf16 v[64:79], v[40:43], v[180:183], v[64:79]
    ds_read_b64_tr_b16 v[52:53], v5 offset:49152
    ds_read_b64_tr_b16 v[54:55], v6 offset:49152
    s_add_u32 s45, s45, 4096
    buffer_load_dwordx4 v[148:151], v7, s[40:43], s45 offen offset:0
    s_waitcnt lgkmcnt(4)
    v_mfma_f32_32x32x16_bf16 v[80:95], v[44:47], v[180:183], v[80:95]
    ds_read_b64_tr_b16 v[56:57], v5 offset:53248
    ds_read_b64_tr_b16 v[58:59], v6 offset:53248
    buffer_load_dwordx4 v[152:155], v7, s[40:43], s45 offen offset:2048
    s_waitcnt lgkmcnt(4)
    v_mfma_f32_32x32x16_bf16 v[96:111], v[48:51], v[180:183], v[96:111]
    ds_read_b64_tr_b16 v[60:61], v5 offset:57344
    ds_read_b64_tr_b16 v[62:63], v6 offset:57344
    s_waitcnt vmcnt(24) lgkmcnt(4)
    v_mfma_f32_32x32x16_bf16 v[64:79], v[52:55], v[184:187], v[64:79]
    ds_read_b64_tr_b16 v[40:41], v3 offset:51200
    ds_read_b64_tr_b16 v[42:43], v4 offset:51200
    s_add_u32 s45, s45, 4096
    buffer_load_dwordx4 v[156:159], v7, s[40:43], s45 offen offset:0
    s_waitcnt lgkmcnt(4)
    v_mfma_f32_32x32x16_bf16 v[80:95], v[56:59], v[184:187], v[80:95]
    ds_read_b64_tr_b16 v[44:45], v3 offset:55296
    ds_read_b64_tr_b16 v[46:47], v4 offset:55296
    buffer_load_dwordx4 v[160:163], v7, s[40:43], s45 offen offset:2048
    s_waitcnt lgkmcnt(4)
    v_mfma_f32_32x32x16_bf16 v[96:111], v[60:63], v[184:187], v[96:111]
    ds_read_b64_tr_b16 v[48:49], v3 offset:59392
    ds_read_b64_tr_b16 v[50:51], v4 offset:59392
    s_waitcnt vmcnt(25) lgkmcnt(4)
    v_mfma_f32_32x32x16_bf16 v[64:79], v[40:43], v[188:191], v[64:79]
    ds_read_b64_tr_b16 v[52:53], v5 offset:51200
    ds_read_b64_tr_b16 v[54:55], v6 offset:51200
    s_add_u32 s45, s45, 4096
    buffer_load_dwordx4 v[164:167], v7, s[40:43], s45 offen offset:0
    s_waitcnt lgkmcnt(4)
    v_mfma_f32_32x32x16_bf16 v[80:95], v[44:47], v[188:191], v[80:95]
    ds_read_b64_tr_b16 v[56:57], v5 offset:55296
    ds_read_b64_tr_b16 v[58:59], v6 offset:55296
    buffer_load_dwordx4 v[168:171], v7, s[40:43], s45 offen offset:2048
    s_waitcnt lgkmcnt(4)
    v_mfma_f32_32x32x16_bf16 v[96:111], v[48:51], v[188:191], v[96:111]
    ds_read_b64_tr_b16 v[60:61], v5 offset:59392
    ds_read_b64_tr_b16 v[62:63], v6 offset:59392
    s_cmp_lg_u32 s67, 0
    s_cbranch_scc1 L_cc55
    s_mov_b32 s56, 4000000
L_lw56:
    ds_read_b32 v255, v10 offset:20
    s_waitcnt lgkmcnt(0)
    v_readfirstlane_b32 s76, v255
    s_nop 0
    s_cmp_ge_u32 s76, s55
    s_cbranch_scc1 L_lwd56
    s_sub_u32 s56, s56, 1
    s_cbranch_scc0 L_lw56
L_lwd56:
L_cc55:
    v_add_u32 v3, 61440, v3
    v_add_u32 v4, 61440, v4
    v_add_u32 v5, 61440, v5
    v_add_u32 v6, 61440, v6
    s_waitcnt vmcnt(26) lgkmcnt(4)
    v_mfma_f32_32x32x16_bf16 v[64:79], v[52:55], v[192:195], v[64:79]
    ds_read_b64_tr_b16 v[40:41], v3 offset:0
    ds_read_b64_tr_b16 v[42:43], v4 offset:0
    s_add_u32 s45, s45, 4096
    buffer_load_dwordx4 v[172:175], v7, s[40:43], s45 offen offset:0
    s_waitcnt lgkmcnt(4)
    v_mfma_f32_32x32x16_bf16 v[80:95], v[56:59], v[192:195], v[80:95]
    ds_read_b64_tr_b16 v[44:45], v3 offset:4096
    ds_read_b64_tr_b16 v[46:47], v4 offset:4096
    buffer_load_dwordx4 v[176:179], v7, s[40:43], s45 offen offset:2048
    s_waitcnt lgkmcnt(4)
    v_mfma_f32_32x32x16_bf16 v[96:111], v[60:63], v[192:195], v[96:111]
    ds_read_b64_tr_b16 v[48:49], v3 offset:8192
    ds_read_b64_tr_b16 v[50:51], v4 offset:8192
    s_cmp_lg_u32 s67, 0
    s_cbranch_scc1 L_cc57
    s_mov_b32 s56, 4000000
L_lw58:
    ds_read_b32 v255, v10 offset:20
    s_waitcnt lgkmcnt(0)
    v_readfirstlane_b32 s76, v255
    s_nop 0
    s_cmp_ge_u32 s76, s55
    s_cbranch_scc1 L_lwd58
    s_sub_u32 s56, s56, 1
    s_cbranch_scc0 L_lw58
L_lwd58:
L_cc57:
    s_cmp_lg_u32 s67, 0
    s_cbranch_scc1 L_cc59
    s_mov_b32 s56, 4000000
L_lw60:
    ds_read_b32 v255, v10 offset:24
    s_waitcnt lgkmcnt(0)
    v_readfirstlane_b32 s76, v255
    s_nop 0
    s_cmp_ge_u32 s76, s55
    s_cbranch_scc1 L_lwd60
    s_sub_u32 s56, s56, 1
    s_cbranch_scc0 L_lw60
L_lwd60:
L_cc59:
    s_cmp_lg_u32 s67, 0
    s_cbranch_scc1 L_cc61
    s_mov_b32 s56, 4000000
L_lw62:
    ds_read_b32 v255, v10 offset:28
    s_waitcnt lgkmcnt(0)
    v_readfirstlane_b32 s76, v255
    s_nop 0
    s_cmp_ge_u32 s76, s55
    s_cbranch_scc1 L_lwd62
    s_sub_u32 s56, s56, 1
    s_cbranch_scc0 L_lw62
L_lwd62:
L_cc61:
    ds_read_b64_tr_b16 v[180:181], v8 offset:0
    ds_read_b64_tr_b16 v[182:183], v8 offset:1024
    ds_read_b64_tr_b16 v[184:185], v8 offset:2048
    ds_read_b64_tr_b16 v[186:187], v8 offset:3072
    s_waitcnt vmcnt(27) lgkmcnt(8)
    v_mfma_f32_32x32x16_bf16 v[64:79], v[40:43], v[196:199], v[64:79]
    ds_read_b64_tr_b16 v[52:53], v5 offset:0
    ds_read_b64_tr_b16 v[54:55], v6 offset:0
    s_waitcnt vmcnt(15) lgkmcnt(4)
    v_mfma_f32_16x16x32_bf16 v[112:115], v[180:183], v[116:119], 0
    v_mfma_f32_32x32x16_bf16 v[80:95], v[44:47], v[196:199], v[80:95]
    ds_read_b64_tr_b16 v[56:57], v5 offset:4096
    ds_read_b64_tr_b16 v[58:59], v6 offset:4096
    s_waitcnt vmcnt(14) lgkmcnt(4)
    v_mfma_f32_16x16x32_bf16 v[112:115], v[184:187], v[120:123], v[112:115]
    v_mfma_f32_32x32x16_bf16 v[96:111], v[48:51], v[196:199], v[96:111]
    ds_read_b64_tr_b16 v[60:61], v5 offset:8192
    ds_read_b64_tr_b16 v[62:63], v6 offset:8192
    ds_read_b64_tr_b16 v[188:189], v8 offset:12288
    ds_read_b64_tr_b16 v[190:191], v8 offset:13312
    ds_read_b64_tr_b16 v[192:193], v8 offset:14336
    ds_read_b64_tr_b16 v[194:195], v8 offset:15360
    s_waitcnt lgkmcnt(8)
    v_mfma_f32_32x32x16_bf16 v[64:79], v[52:55], v[200:203], v[64:79]
    ds_read_b64_tr_b16 v[40:41], v3 offset:2048
    ds_read_b64_tr_b16 v[42:43], v4 offset:2048
    s_waitcnt vmcnt(13) lgkmcnt(4)
    v_mfma_f32_16x16x32_bf16 v[112:115], v[188:191], v[124:127], v[112:115]
    v_mfma_f32_32x32x16_bf16 v[80:95], v[56:59], v[200:203], v[80:95]
    ds_read_b64_tr_b16 v[44:45], v3 offset:6144
    ds_read_b64_tr_b16 v[46:47], v4 offset:6144
    s_waitcnt vmcnt(12) lgkmcnt(4)
    v_mfma_f32_16x16x32_bf16 v[112:115], v[192:195], v[128:131], v[112:115]
    v_mfma_f32_32x32x16_bf16 v[96:111], v[60:63], v[200:203], v[96:111]
    ds_read_b64_tr_b16 v[48:49], v3 offset:10240
    ds_read_b64_tr_b16 v[50:51], v4 offset:10240
    ds_read_b64_tr_b16 v[180:181], v8 offset:24576
    ds_read_b64_tr_b16 v[182:183], v8 offset:25600
    ds_read_b64_tr_b16 v[184:185], v8 offset:26624
    ds_read_b64_tr_b16 v[186:187], v8 offset:27648
    s_waitcnt lgkmcnt(8)
    v_mfma_f32_32x32x16_bf16 v[64:79], v[40:43], v[204:207], v[64:79]
    ds_read_b64_tr_b16 v[52:53], v5 offset:2048
    ds_read_b64_tr_b16 v[54:55], v6 offset:2048
    s_waitcnt vmcnt(11) lgkmcnt(4)
    v_mfma_f32_16x16x32_bf16 v[112:115], v[180:183], v[132:135], v[112:115]
    v_mfma_f32_32x32x16_bf16 v[80:95], v[44:47], v[204:207], v[80:95]
    ds_read_b64_tr_b16 v[56:57], v5 offset:6144
    ds_read_b64_tr_b16 v[58:59], v6 offset:6144
    s_waitcnt vmcnt(10) lgkmcnt(4)
    v_mfma_f32_16x16x32_bf16 v[112:115], v[184:187], v[136:139], v[112:115]
    v_mfma_f32_32x32x16_bf16 v[96:111], v[48:51], v[204:207], v[96:111]
    ds_read_b64_tr_b16 v[60:61], v5 offset:10240
    ds_read_b64_tr_b16 v[62:63], v6 offset:10240
    ds_read_b64_tr_b16 v[188:189], v8 offset:36864
    ds_read_b64_tr_b16 v[190:191], v8 offset:37888
    ds_read_b64_tr_b16 v[192:193], v8 offset:38912
    ds_read_b64_tr_b16 v[194:195], v8 offset:39936
    s_cmp_lg_u32 s67, 0
    s_cbranch_scc1 L_cc63
    s_mov_b32 s56, 4000000
L_lw64:
    ds_read_b32 v255, v10 offset:24
    s_waitcnt lgkmcnt(0)
    v_readfirstlane_b32 s76, v255
    s_nop 0
    s_cmp_ge_u32 s76, s55
    s_cbranch_scc1 L_lwd64
    s_sub_u32 s56, s56, 1
    s_cbranch_scc0 L_lw64
L_lwd64:
L_cc63:
    s_waitcnt lgkmcnt(8)
    v_mfma_f32_32x32x16_bf16 v[64:79], v[52:55], v[208:211], v[64:79]
    ds_read_b64_tr_b16 v[40:41], v3 offset:12288
    ds_read_b64_tr_b16 v[42:43], v4 offset:12288
    s_waitcnt vmcnt(9) lgkmcnt(4)
    v_mfma_f32_16x16x32_bf16 v[112:115], v[188:191], v[140:143], v[112:115]
    v_mfma_f32_32x32x16_bf16 v[80:95], v[56:59], v[208:211], v[80:95]
    ds_read_b64_tr_b16 v[44:45], v3 offset:16384
    ds_read_b64_tr_b16 v[46:47], v4 offset:16384
    s_waitcnt vmcnt(8) lgkmcnt(4)
    v_mfma_f32_16x16x32_bf16 v[112:115], v[192:195], v[144:147], v[112:115]
    v_mfma_f32_32x32x16_bf16 v[96:111], v[60:63], v[208:211], v[96:111]
    ds_read_b64_tr_b16 v[48:49], v3 offset:20480
    ds_read_b64_tr_b16 v[50:51], v4 offset:20480
    ds_read_b64_tr_b16 v[180:181], v8 offset:49152
    ds_read_b64_tr_b16 v[182:183], v8 offset:50176
    ds_read_b64_tr_b16 v[184:185], v8 offset:51200
    ds_read_b64_tr_b16 v[186:187], v8 offset:52224
    s_mov_b64 exec, 1
    ds_add_u32 v10, v11 offset:52
    s_mov_b64 exec, -1
    s_waitcnt lgkmcnt(9)
    v_mfma_f32_32x32x16_bf16 v[64:79], v[40:43], v[212:215], v[64:79]
    ds_read_b64_tr_b16 v[52:53], v5 offset:12288
    ds_read_b64_tr_b16 v[54:55], v6 offset:12288
    s_waitcnt vmcnt(7) lgkmcnt(5)
    v_mfma_f32_16x16x32_bf16 v[112:115], v[180:183], v[148:151], v[112:115]
    v_mfma_f32_32x32x16_bf16 v[80:95], v[44:47], v[212:215], v[80:95]
    ds_read_b64_tr_b16 v[56:57], v5 offset:16384
    ds_read_b64_tr_b16 v[58:59], v6 offset:16384
    s_waitcnt vmcnt(6) lgkmcnt(5)
    v_mfma_f32_16x16x32_bf16 v[112:115], v[184:187], v[152:155], v[112:115]
    v_mfma_f32_32x32x16_bf16 v[96:111], v[48:51], v[212:215], v[96:111]
    ds_read_b64_tr_b16 v[60:61], v5 offset:20480
    ds_read_b64_tr_b16 v[62:63], v6 offset:20480
    ds_read_b64_tr_b16 v[188:189], v9 offset:0
    ds_read_b64_tr_b16 v[190:191], v9 offset:1024
    ds_read_b64_tr_b16 v[192:193], v9 offset:2048
    ds_read_b64_tr_b16 v[194:195], v9 offset:3072
    s_waitcnt lgkmcnt(8)
    v_mfma_f32_32x32x16_bf16 v[64:79], v[52:55], v[216:219], v[64:79]
    ds_read_b64_tr_b16 v[40:41], v3 offset:14336
    ds_read_b64_tr_b16 v[42:43], v4 offset:14336
    s_waitcnt vmcnt(5) lgkmcnt(4)
    v_mfma_f32_16x16x32_bf16 v[112:115], v[188:191], v[156:159], v[112:115]
    v_mfma_f32_32x32x16_bf16 v[80:95], v[56:59], v[216:219], v[80:95]
    ds_read_b64_tr_b16 v[44:45], v3 offset:18432
    ds_read_b64_tr_b16 v[46:47], v4 offset:18432
    s_waitcnt vmcnt(4) lgkmcnt(4)
    v_mfma_f32_16x16x32_bf16 v[112:115], v[192:195], v[160:163], v[112:115]
    v_mfma_f32_32x32x16_bf16 v[96:111], v[60:63], v[216:219], v[96:111]
    ds_read_b64_tr_b16 v[48:49], v3 offset:22528
    ds_read_b64_tr_b16 v[50:51], v4 offset:22528
    ds_read_b64_tr_b16 v[180:181], v9 offset:12288
    ds_read_b64_tr_b16 v[182:183], v9 offset:13312
    ds_read_b64_tr_b16 v[184:185], v9 offset:14336
    ds_read_b64_tr_b16 v[186:187], v9 offset:15360
    s_waitcnt lgkmcnt(8)
    v_mfma_f32_32x32x16_bf16 v[64:79], v[40:43], v[220:223], v[64:79]
    ds_read_b64_tr_b16 v[52:53], v5 offset:14336
    ds_read_b64_tr_b16 v[54:55], v6 offset:14336
    s_waitcnt vmcnt(3) lgkmcnt(4)
    v_mfma_f32_16x16x32_bf16 v[112:115], v[180:183], v[164:167], v[112:115]
    v_mfma_f32_32x32x16_bf16 v[80:95], v[44:47], v[220:223], v[80:95]
    ds_read_b64_tr_b16 v[56:57], v5 offset:18432
    ds_read_b64_tr_b16 v[58:59], v6 offset:18432
    s_waitcnt vmcnt(2) lgkmcnt(4)
    v_mfma_f32_16x16x32_bf16 v[112:115], v[184:187], v[168:171], v[112:115]
    v_mfma_f32_32x32x16_bf16 v[96:111], v[48:51], v[220:223], v[96:111]
    ds_read_b64_tr_b16 v[60:61], v5 offset:22528
    ds_read_b64_tr_b16 v[62:63], v6 offset:22528
    ds_read_b64_tr_b16 v[188:189], v9 offset:24576
    ds_read_b64_tr_b16 v[190:191], v9 offset:25600
    ds_read_b64_tr_b16 v[192:193], v9 offset:26624
    ds_read_b64_tr_b16 v[194:195], v9 offset:27648
    s_cmp_lg_u32 s67, 0
    s_cbranch_scc1 L_cc65
    s_mov_b32 s56, 4000000
L_lw66:
    ds_read_b32 v255, v10 offset:28
    s_waitcnt lgkmcnt(0)
    v_readfirstlane_b32 s76, v255
    s_nop 0
    s_cmp_ge_u32 s76, s55
    s_cbranch_scc1 L_lwd66
    s_sub_u32 s56, s56, 1
    s_cbranch_scc0 L_lw66
L_lwd66:
L_cc65:
    s_waitcnt lgkmcnt(8)
    v_mfma_f32_32x32x16_bf16 v[64:79], v[52:55], v[224:227], v[64:79]
    ds_read_b64_tr_b16 v[40:41], v3 offset:24576
    ds_read_b64_tr_b16 v[42:43], v4 offset:24576
    s_waitcnt vmcnt(1) lgkmcnt(4)
    v_mfma_f32_16x16x32_bf16 v[112:115], v[188:191], v[172:175], v[112:115]
    v_mfma_f32_32x32x16_bf16 v[80:95], v[56:59], v[224:227], v[80:95]
    ds_read_b64_tr_b16 v[44:45], v3 offset:28672
    ds_read_b64_tr_b16 v[46:47], v4 offset:28672
    s_waitcnt vmcnt(0) lgkmcnt(4)
    v_mfma_f32_16x16x32_bf16 v[112:115], v[192:195], v[176:179], v[112:115]
    v_mfma_f32_32x32x16_bf16 v[96:111], v[60:63], v[224:227], v[96:111]
    ds_read_b64_tr_b16 v[48:49], v3 offset:32768
    ds_read_b64_tr_b16 v[50:51], v4 offset:32768
    s_waitcnt lgkmcnt(4)
    v_mfma_f32_32x32x16_bf16 v[64:79], v[40:43], v[228:231], v[64:79]
    ds_read_b64_tr_b16 v[52:53], v5 offset:24576
    ds_read_b64_tr_b16 v[54:55], v6 offset:24576
    s_waitcnt lgkmcnt(4)
    v_mfma_f32_32x32x16_bf16 v[80:95], v[44:47], v[228:231], v[80:95]
    ds_read_b64_tr_b16 v[56:57], v5 offset:28672
    ds_read_b64_tr_b16 v[58:59], v6 offset:28672
    s_waitcnt lgkmcnt(4)
    v_mfma_f32_32x32x16_bf16 v[96:111], v[48:51], v[228:231], v[96:111]
    ds_read_b64_tr_b16 v[60:61], v5 offset:32768
    ds_read_b64_tr_b16 v[62:63], v6 offset:32768
    s_waitcnt lgkmcnt(4)
    v_mfma_f32_32x32x16_bf16 v[64:79], v[52:55], v[232:235], v[64:79]
    ds_read_b64_tr_b16 v[40:41], v3 offset:26624
    ds_read_b64_tr_b16 v[42:43], v4 offset:26624
    s_waitcnt lgkmcnt(4)
    v_mfma_f32_32x32x16_bf16 v[80:95], v[56:59], v[232:235], v[80:95]
    ds_read_b64_tr_b16 v[44:45], v3 offset:30720
    ds_read_b64_tr_b16 v[46:47], v4 offset:30720
    s_waitcnt lgkmcnt(4)
    v_mfma_f32_32x32x16_bf16 v[96:111], v[60:63], v[232:235], v[96:111]
    ds_read_b64_tr_b16 v[48:49], v3 offset:34816
    ds_read_b64_tr_b16 v[50:51], v4 offset:34816
    ds_read_b32 v15, v10 offset:32
    ds_read_b128 v[228:231], v13
    ds_read_b128 v[196:199], v14 offset:128
    ds_read_b128 v[200:203], v14 offset:160
    ds_read_b128 v[204:207], v14 offset:192
    ds_read_b128 v[208:211], v14 offset:224
    ds_read_b128 v[212:215], v14 offset:256
    ds_read_b128 v[216:219], v14 offset:288
    ds_read_b128 v[220:223], v14 offset:320
    ds_read_b128 v[224:227], v14 offset:352
    ds_read_b128 v[180:183], v14 offset:0
    ds_read_b128 v[184:187], v14 offset:32
    ds_read_b128 v[188:191], v14 offset:64
    ds_read_b128 v[192:195], v14 offset:96
    s_waitcnt lgkmcnt(15)
    v_mfma_f32_32x32x16_bf16 v[64:79], v[40:43], v[236:239], v[64:79]
    ds_read_b64_tr_b16 v[52:53], v5 offset:26624
    ds_read_b64_tr_b16 v[54:55], v6 offset:26624
    s_waitcnt lgkmcnt(15)
    v_mfma_f32_32x32x16_bf16 v[80:95], v[44:47], v[236:239], v[80:95]
    ds_read_b64_tr_b16 v[56:57], v5 offset:30720
    ds_read_b64_tr_b16 v[58:59], v6 offset:30720
    s_waitcnt lgkmcnt(15)
    v_mfma_f32_32x32x16_bf16 v[96:111], v[48:51], v[236:239], v[96:111]
    ds_read_b64_tr_b16 v[60:61], v5 offset:34816
    ds_read_b64_tr_b16 v[62:63], v6 offset:34816
    s_waitcnt lgkmcnt(4)
    v_mfma_f32_32x32x16_bf16 v[64:79], v[52:55], v[240:243], v[64:79]
    s_waitcnt lgkmcnt(2)
    v_mfma_f32_32x32x16_bf16 v[80:95], v[56:59], v[240:243], v[80:95]
    s_waitcnt lgkmcnt(0)
    v_mfma_f32_32x32x16_bf16 v[96:111], v[60:63], v[240:243], v[96:111]
    v_subrev_u32 v3, 61440, v3
    v_subrev_u32 v4, 61440, v4
    v_subrev_u32 v5, 61440, v5
    v_subrev_u32 v6, 61440, v6
    s_waitcnt lgkmcnt(0)
    s_mov_b64 exec, 1
    ds_add_u32 v10, v11 offset:36
    s_mov_b64 exec, -1
    v_readfirstlane_b32 s76, v15
    s_nop 0
    s_cmp_ge_u32 s76, s55
    s_cbranch_scc1 L_cf67
    s_mov_b32 s56, 4000000
L_lw68:
    ds_read_b32 v15, v10 offset:32
    s_waitcnt lgkmcnt(0)
    v_readfirstlane_b32 s76, v15
    s_nop 0
    s_cmp_ge_u32 s76, s55
    s_cbranch_scc1 L_lwd68
    s_sub_u32 s56, s56, 1
    s_cbranch_scc0 L_lw68
L_lwd68:
    ds_read_b128 v[228:231], v13
    ds_read_b128 v[196:199], v14 offset:128
    ds_read_b128 v[200:203], v14 offset:160
    ds_read_b128 v[204:207], v14 offset:192
    ds_read_b128 v[208:211], v14 offset:224
    ds_read_b128 v[212:215], v14 offset:256
    ds_read_b128 v[216:219], v14 offset:288
    ds_read_b128 v[220:223], v14 offset:320
    ds_read_b128 v[224:227], v14 offset:352
    ds_read_b128 v[180:183], v14 offset:0
    ds_read_b128 v[184:187], v14 offset:32
    ds_read_b128 v[188:191], v14 offset:64
    ds_read_b128 v[192:195], v14 offset:96
    s_waitcnt lgkmcnt(0)
L_cf67:
    s_nop 3
    s_lshr_b32 s73, s72, 1
    s_and_b32 s74, s72, 1
    s_lshl_b32 s75, s73, 7
    s_lshl_b32 s54, s74, 6
    s_add_u32 s75, s75, s54
    v_bfe_u32 v241, v1, 4, 2
    v_lshlrev_b32 v241, 4, v241
    v_add_u32 v241, 159872, v241
    v_add_u32 v241, s75, v241
    v_and_b32 v240, 15, v1
    v_lshlrev_b32 v240, 4, v240
    v_add_u32 v240, 160512, v240
    ds_read_b128 v[236:239], v241
    ds_read_b128 v[232:235], v240
    s_lshl_b32 s75, s72, 9
    v_and_b32 v242, 31, v1
    v_lshlrev_b32 v242, 4, v242
    v_bfe_u32 v255, v1, 5, 1
    v_mul_u32_u24 v255, 2304, v255
    v_add_u32 v242, v255, v242
    v_add_u32 v242, 61472, v242
    v_add_u32 v242, s75, v242
    v_pk_mul_f32 v[196:197], v[196:197], v[228:229] op_sel:[0,1] op_sel_hi:[1,1]
    v_pk_mul_f32 v[198:199], v[198:199], v[228:229] op_sel:[0,1] op_sel_hi:[1,1]
    v_pk_mul_f32 v[200:201], v[200:201], v[228:229] op_sel:[0,1] op_sel_hi:[1,1]
    v_pk_mul_f32 v[202:203], v[202:203], v[228:229] op_sel:[0,1] op_sel_hi:[1,1]
    v_pk_mul_f32 v[204:205], v[204:205], v[228:229] op_sel:[0,1] op_sel_hi:[1,1]
    v_pk_mul_f32 v[206:207], v[206:207], v[228:229] op_sel:[0,1] op_sel_hi:[1,1]
    v_pk_mul_f32 v[208:209], v[208:209], v[228:229] op_sel:[0,1] op_sel_hi:[1,1]
    v_pk_mul_f32 v[210:211], v[210:211], v[228:229] op_sel:[0,1] op_sel_hi:[1,1]
    v_pk_fma_f32 v[80:81], v[80:81], v[228:229], v[196:197] op_sel_hi:[1,0,1]
    v_pk_fma_f32 v[82:83], v[82:83], v[228:229], v[198:199] op_sel_hi:[1,0,1]
    v_pk_fma_f32 v[84:85], v[84:85], v[228:229], v[200:201] op_sel_hi:[1,0,1]
    v_pk_fma_f32 v[86:87], v[86:87], v[228:229], v[202:203] op_sel_hi:[1,0,1]
    v_pk_fma_f32 v[88:89], v[88:89], v[228:229], v[204:205] op_sel_hi:[1,0,1]
    v_pk_fma_f32 v[90:91], v[90:91], v[228:229], v[206:207] op_sel_hi:[1,0,1]
    v_pk_fma_f32 v[92:93], v[92:93], v[228:229], v[208:209] op_sel_hi:[1,0,1]
    v_pk_fma_f32 v[94:95], v[94:95], v[228:229], v[210:211] op_sel_hi:[1,0,1]
    v_cvt_pk_bf16_f32 v48, v80, v81
    v_cvt_pk_bf16_f32 v49, v82, v83
    v_cvt_pk_bf16_f32 v50, v84, v85
    v_cvt_pk_bf16_f32 v51, v86, v87
    v_cvt_pk_bf16_f32 v52, v88, v89
    v_cvt_pk_bf16_f32 v53, v90, v91
    v_cvt_pk_bf16_f32 v54, v92, v93
    v_cvt_pk_bf16_f32 v55, v94, v95
    ds_read_b32 v15, v10 offset:36
    v_pk_mul_f32 v[212:213], v[212:213], v[228:229] op_sel:[0,1] op_sel_hi:[1,1]
    v_pk_mul_f32 v[214:215], v[214:215], v[228:229] op_sel:[0,1] op_sel_hi:[1,1]
    v_pk_mul_f32 v[216:217], v[216:217], v[228:229] op_sel:[0,1] op_sel_hi:[1,1]
    v_pk_mul_f32 v[218:219], v[218:219], v[228:229] op_sel:[0,1] op_sel_hi:[1,1]
    v_pk_mul_f32 v[220:221], v[220:221], v[228:229] op_sel:[0,1] op_sel_hi:[1,1]
    v_pk_mul_f32 v[222:223], v[222:223], v[228:229] op_sel:[0,1] op_sel_hi:[1,1]
    v_pk_mul_f32 v[224:225], v[224:225], v[228:229] op_sel:[0,1] op_sel_hi:[1,1]
    v_pk_mul_f32 v[226:227], v[226:227], v[228:229] op_sel:[0,1] op_sel_hi:[1,1]
    v_pk_fma_f32 v[96:97], v[96:97], v[228:229], v[212:213] op_sel_hi:[1,0,1]
    v_pk_fma_f32 v[98:99], v[98:99], v[228:229], v[214:215] op_sel_hi:[1,0,1]
    v_pk_fma_f32 v[100:101], v[100:101], v[228:229], v[216:217] op_sel_hi:[1,0,1]
    v_pk_fma_f32 v[102:103], v[102:103], v[228:229], v[218:219] op_sel_hi:[1,0,1]
    v_pk_fma_f32 v[104:105], v[104:105], v[228:229], v[220:221] op_sel_hi:[1,0,1]
    v_pk_fma_f32 v[106:107], v[106:107], v[228:229], v[222:223] op_sel_hi:[1,0,1]
    v_pk_fma_f32 v[108:109], v[108:109], v[228:229], v[224:225] op_sel_hi:[1,0,1]
    v_pk_fma_f32 v[110:111], v[110:111], v[228:229], v[226:227] op_sel_hi:[1,0,1]
    v_permlane32_swap_b32 v48, v52
    v_permlane32_swap_b32 v49, v53
    v_permlane32_swap_b32 v50, v54
    v_permlane32_swap_b32 v51, v55
    v_permlane32_swap_b32 v96, v104
    v_permlane32_swap_b32 v97, v105
    v_permlane32_swap_b32 v98, v106
    v_permlane32_swap_b32 v99, v107
    v_permlane32_swap_b32 v100, v108
    v_permlane32_swap_b32 v101, v109
    v_permlane32_swap_b32 v102, v110
    v_permlane32_swap_b32 v103, v111
    s_waitcnt lgkmcnt(0)
    v_pk_mul_f32 v[236:237], v[236:237], v[232:233] op_sel:[0,1] op_sel_hi:[1,1]
    v_pk_mul_f32 v[238:239], v[238:239], v[232:233] op_sel:[0,1] op_sel_hi:[1,1]
    v_pk_fma_f32 v[112:113], v[112:113], v[232:233], v[236:237] op_sel_hi:[1,0,1]
    v_pk_fma_f32 v[114:115], v[114:115], v[232:233], v[238:239] op_sel_hi:[1,0,1]
    v_readfirstlane_b32 s76, v15
    s_nop 0
    s_cmp_ge_u32 s76, s55
    s_cbranch_scc1 L_cf69
    s_mov_b32 s56, 4000000
L_lw70:
    ds_read_b32 v15, v10 offset:36
    s_waitcnt lgkmcnt(0)
    v_readfirstlane_b32 s76, v15
    s_nop 0
    s_cmp_ge_u32 s76, s55
    s_cbranch_scc1 L_lwd70
    s_sub_u32 s56, s56, 1
    s_cbranch_scc0 L_lw70
L_lwd70:
L_cf69:
    ds_write_b128 v242, v[48:51] offset:224
    ds_write_b128 v242, v[52:55] offset:4832
    ds_write_b128 v242, v[96:99] offset:9440
    ds_write_b128 v242, v[100:103] offset:14048
    ds_write_b128 v242, v[104:107] offset:18656
    ds_write_b128 v242, v[108:111] offset:23264
    s_mul_i32 s54, s74, 2304
    s_cmp_eq_u32 s73, 0
    s_cbranch_scc0 L_B_halo_v
    v_bfe_u32 v243, v1, 4, 1
    v_mul_u32_u24 v243, 4608, v243
    v_and_b32 v15, 15, v1
    v_lshl_add_u32 v243, v15, 4, v243
    v_bfe_u32 v15, v1, 5, 1
    v_lshl_add_u32 v243, v15, 3, v243
    v_add_u32 v243, 61440, v243
    v_add_u32 v243, s54, v243
    v_cvt_pk_bf16_f32 v236, v112, v113
    v_cvt_pk_bf16_f32 v237, v114, v115
    ds_write_b64 v243, v[236:237]
    s_branch L_B_halo_done
L_B_halo_v:
    v_bfe_u32 v243, v1, 5, 1
    v_mul_u32_u24 v243, 4608, v243
    v_bfe_u32 v15, v1, 4, 1
    v_mul_u32_u24 v15, 9216, v15
    v_add_u32 v243, v15, v243
    v_and_b32 v15, 15, v1
    v_lshl_add_u32 v243, v15, 4, v243
    v_add_u32 v243, 70656, v243
    v_add_u32 v243, s54, v243
    ds_write_b128 v243, v[112:115]
L_B_halo_done:
    s_mov_b64 exec, 1
    ds_add_u32 v10, v11 offset:56
    s_mov_b64 exec, -1
    v_pk_fma_f32 v[64:65], v[180:181], v[230:231], v[64:65] op_sel_hi:[1,0,1]
    v_pk_fma_f32 v[66:67], v[182:183], v[230:231], v[66:67] op_sel_hi:[1,0,1]
    v_pk_fma_f32 v[68:69], v[184:185], v[230:231], v[68:69] op_sel_hi:[1,0,1]
    v_pk_fma_f32 v[70:71], v[186:187], v[230:231], v[70:71] op_sel_hi:[1,0,1]
    v_pk_fma_f32 v[72:73], v[188:189], v[230:231], v[72:73] op_sel_hi:[1,0,1]
    v_pk_fma_f32 v[74:75], v[190:191], v[230:231], v[74:75] op_sel_hi:[1,0,1]
    v_pk_fma_f32 v[76:77], v[192:193], v[230:231], v[76:77] op_sel_hi:[1,0,1]
    v_pk_fma_f32 v[78:79], v[194:195], v[230:231], v[78:79] op_sel_hi:[1,0,1]
    v_cvt_pk_bf16_f32 v40, v64, v65
    v_cvt_pk_bf16_f32 v41, v66, v67
    v_cvt_pk_bf16_f32 v42, v68, v69
    v_cvt_pk_bf16_f32 v43, v70, v71
    v_cvt_pk_bf16_f32 v44, v72, v73
    v_cvt_pk_bf16_f32 v45, v74, v75
    v_cvt_pk_bf16_f32 v46, v76, v77
    v_cvt_pk_bf16_f32 v47, v78, v79
    v_permlane32_swap_b32 v40, v44
    v_permlane32_swap_b32 v41, v45
    v_permlane32_swap_b32 v42, v46
    v_permlane32_swap_b32 v43, v47
    v_mul_f32 v232, 0x3eb8aa3b, v228
    v_dot2_f32_bf16 v172, v40, v48, 0
    s_nop 2
    v_dot2c_f32_bf16 v172, v41, v49
    v_dot2c_f32_bf16 v172, v42, v50
    v_dot2c_f32_bf16 v172, v43, v51
    v_dot2c_f32_bf16 v172, v44, v52
    v_dot2c_f32_bf16 v172, v45, v53
    v_dot2c_f32_bf16 v172, v46, v54
    v_dot2c_f32_bf16 v172, v47, v55
    s_mov_b32 s56, 4000000
L_lw71:
    ds_read_b32 v15, v10 offset:56
    s_waitcnt lgkmcnt(0)
    v_readfirstlane_b32 s76, v15
    s_nop 0
    s_cmp_ge_u32 s76, s55
    s_cbranch_scc1 L_lwd71
    s_sub_u32 s56, s56, 1
    s_cbranch_scc0 L_lw71
L_lwd71:
    ds_read_b128 v[116:119], v242 offset:192
    ds_read_b128 v[120:123], v242 offset:4800
    ds_read_b128 v[124:127], v242 offset:160
    ds_read_b128 v[128:131], v242 offset:4768
    ds_read_b128 v[132:135], v242 offset:128
    ds_read_b128 v[136:139], v242 offset:4736
    ds_read_b128 v[140:143], v242 offset:96
    ds_read_b128 v[144:147], v242 offset:4704
    ds_read_b128 v[148:151], v242 offset:64
    ds_read_b128 v[152:155], v242 offset:4672
    ds_read_b128 v[156:159], v242 offset:32
    ds_read_b128 v[160:163], v242 offset:4640
    ds_read_b128 v[164:167], v242 offset:0
    ds_read_b128 v[168:171], v242 offset:4608
    s_waitcnt lgkmcnt(6)
    v_dot2_f32_bf16 v173, v40, v116, 0
    v_dot2_f32_bf16 v174, v40, v124, 0
    v_dot2_f32_bf16 v175, v40, v132, 0
    v_dot2_f32_bf16 v176, v40, v140, 0
    v_dot2c_f32_bf16 v173, v41, v117
    v_dot2c_f32_bf16 v174, v41, v125
    v_dot2c_f32_bf16 v175, v41, v133
    v_dot2c_f32_bf16 v176, v41, v141
    v_dot2c_f32_bf16 v173, v42, v118
    v_dot2c_f32_bf16 v174, v42, v126
    v_dot2c_f32_bf16 v175, v42, v134
    v_dot2c_f32_bf16 v176, v42, v142
    v_dot2c_f32_bf16 v173, v43, v119
    v_dot2c_f32_bf16 v174, v43, v127
    v_dot2c_f32_bf16 v175, v43, v135
    v_dot2c_f32_bf16 v176, v43, v143
    v_dot2c_f32_bf16 v173, v44, v120
    v_dot2c_f32_bf16 v174, v44, v128
    v_dot2c_f32_bf16 v175, v44, v136
    v_dot2c_f32_bf16 v176, v44, v144
    v_dot2c_f32_bf16 v173, v45, v121
    v_dot2c_f32_bf16 v174, v45, v129
    v_dot2c_f32_bf16 v175, v45, v137
    v_dot2c_f32_bf16 v176, v45, v145
    v_dot2c_f32_bf16 v173, v46, v122
    v_dot2c_f32_bf16 v174, v46, v130
    v_dot2c_f32_bf16 v175, v46, v138
    v_dot2c_f32_bf16 v176, v46, v146
    v_dot2c_f32_bf16 v173, v47, v123
    v_dot2c_f32_bf16 v174, v47, v131
    v_dot2c_f32_bf16 v175, v47, v139
    v_dot2c_f32_bf16 v176, v47, v147
    s_waitcnt lgkmcnt(0)
    ds_read_b128 v[180:183], v242 offset:9408
    ds_read_b128 v[184:187], v242 offset:14016
    ds_read_b128 v[188:191], v242 offset:18624
    ds_read_b128 v[192:195], v242 offset:23232
    ds_read_b128 v[196:199], v242 offset:9376
    ds_read_b128 v[200:203], v242 offset:13984
    ds_read_b128 v[204:207], v242 offset:18592
    ds_read_b128 v[208:211], v242 offset:23200
    ds_read_b128 v[212:215], v242 offset:9344
    ds_read_b128 v[216:219], v242 offset:13952
    ds_read_b128 v[220:223], v242 offset:18560
    ds_read_b128 v[224:227], v242 offset:23168
    v_dot2_f32_bf16 v177, v40, v148, 0
    v_dot2_f32_bf16 v178, v40, v156, 0
    v_dot2_f32_bf16 v179, v40, v164, 0
    s_nop 0
    v_dot2c_f32_bf16 v177, v41, v149
    v_dot2c_f32_bf16 v178, v41, v157
    v_dot2c_f32_bf16 v179, v41, v165
    v_dot2c_f32_bf16 v177, v42, v150
    v_dot2c_f32_bf16 v178, v42, v158
    v_dot2c_f32_bf16 v179, v42, v166
    v_dot2c_f32_bf16 v177, v43, v151
    v_dot2c_f32_bf16 v178, v43, v159
    v_dot2c_f32_bf16 v179, v43, v167
    v_dot2c_f32_bf16 v177, v44, v152
    v_dot2c_f32_bf16 v178, v44, v160
    v_dot2c_f32_bf16 v179, v44, v168
    v_dot2c_f32_bf16 v177, v45, v153
    v_dot2c_f32_bf16 v178, v45, v161
    v_dot2c_f32_bf16 v179, v45, v169
    v_dot2c_f32_bf16 v177, v46, v154
    v_dot2c_f32_bf16 v178, v46, v162
    v_dot2c_f32_bf16 v179, v46, v170
    v_dot2c_f32_bf16 v177, v47, v155
    v_dot2c_f32_bf16 v178, v47, v163
    v_dot2c_f32_bf16 v179, v47, v171
    ds_read_b128 v[64:67], v242 offset:9312
    ds_read_b128 v[68:71], v242 offset:13920
    ds_read_b128 v[72:75], v242 offset:18528
    ds_read_b128 v[76:79], v242 offset:23136
    ds_read_b128 v[80:83], v242 offset:9280
    ds_read_b128 v[84:87], v242 offset:13888
    ds_read_b128 v[88:91], v242 offset:18496
    ds_read_b128 v[92:95], v242 offset:23104
    ds_read_b128 v[116:119], v242 offset:9248
    ds_read_b128 v[120:123], v242 offset:13856
    ds_read_b128 v[124:127], v242 offset:18464
    ds_read_b128 v[128:131], v242 offset:23072
    ds_read_b128 v[132:135], v242 offset:9216
    ds_read_b128 v[136:139], v242 offset:13824
    ds_read_b128 v[140:143], v242 offset:18432
    ds_read_b128 v[144:147], v242 offset:23040
    s_or_b32 s73, s4, s72
    s_cmp_lg_u32 s73, 0
    s_cbranch_scc1 L_B_nomask
    v_and_b32 v15, 31, v1
    v_mov_b32 v255, 0xf149f2ca
    v_cmp_le_u32 vcc, 2, v15
    s_nop 1
    v_cndmask_b32 v173, v255, v173, vcc
    v_cmp_le_u32 vcc, 4, v15
    s_nop 1
    v_cndmask_b32 v174, v255, v174, vcc
    v_cmp_le_u32 vcc, 6, v15
    s_nop 1
    v_cndmask_b32 v175, v255, v175, vcc
    v_cmp_le_u32 vcc, 8, v15
    s_nop 1
    v_cndmask_b32 v176, v255, v176, vcc
    v_cmp_le_u32 vcc, 10, v15
    s_nop 1
    v_cndmask_b32 v177, v255, v177, vcc
    v_cmp_le_u32 vcc, 12, v15
    s_nop 1
    v_cndmask_b32 v178, v255, v178, vcc
    v_cmp_le_u32 vcc, 14, v15
    s_nop 1
    v_cndmask_b32 v179, v255, v179, vcc
L_B_nomask:
    s_nop 2
    v_max3_f32 v228, v172, v173, v174
    v_max3_f32 v228, v228, v175, v176
    v_max3_f32 v228, v228, v177, v178
    v_max_f32 v228, v228, v179
    v_mul_f32 v228, v232, v228
    v_pk_fma_f32 v[172:173], v[172:173], v[232:233], v[228:229] op_sel_hi:[1,0,0] neg_lo:[0,0,1] neg_hi:[0,0,1]
    v_pk_fma_f32 v[174:175], v[174:175], v[232:233], v[228:229] op_sel_hi:[1,0,0] neg_lo:[0,0,1] neg_hi:[0,0,1]
    v_pk_fma_f32 v[176:177], v[176:177], v[232:233], v[228:229] op_sel_hi:[1,0,0] neg_lo:[0,0,1] neg_hi:[0,0,1]
    v_pk_fma_f32 v[178:179], v[178:179], v[232:233], v[228:229] op_sel_hi:[1,0,0] neg_lo:[0,0,1] neg_hi:[0,0,1]
    v_exp_f32 v172, v172
    v_exp_f32 v173, v173
    v_exp_f32 v174, v174
    v_exp_f32 v175, v175
    v_exp_f32 v176, v176
    v_exp_f32 v177, v177
    v_exp_f32 v178, v178
    v_exp_f32 v179, v179
    v_pk_add_f32 v[236:237], v[172:173], v[174:175]
    v_pk_add_f32 v[238:239], v[176:177], v[178:179]
    v_pk_add_f32 v[236:237], v[236:237], v[238:239]
    v_add_f32 v236, v236, v237
    v_rcp_f32 v236, v236
    s_nop 0
    v_pk_mul_f32 v[172:173], v[172:173], v[236:237] op_sel_hi:[1,0]
    v_pk_mul_f32 v[174:175], v[174:175], v[236:237] op_sel_hi:[1,0]
    v_pk_mul_f32 v[176:177], v[176:177], v[236:237] op_sel_hi:[1,0]
    v_pk_mul_f32 v[178:179], v[178:179], v[236:237] op_sel_hi:[1,0]
    v_pk_mul_f32 v[96:97], v[96:97], v[172:173] op_sel_hi:[1,0]
    v_pk_mul_f32 v[98:99], v[98:99], v[172:173] op_sel_hi:[1,0]
    v_pk_mul_f32 v[100:101], v[100:101], v[172:173] op_sel_hi:[1,0]
    v_pk_mul_f32 v[102:103], v[102:103], v[172:173] op_sel_hi:[1,0]
    v_pk_mul_f32 v[104:105], v[104:105], v[172:173] op_sel_hi:[1,0]
    v_pk_mul_f32 v[106:107], v[106:107], v[172:173] op_sel_hi:[1,0]
    v_pk_mul_f32 v[108:109], v[108:109], v[172:173] op_sel_hi:[1,0]
    v_pk_mul_f32 v[110:111], v[110:111], v[172:173] op_sel_hi:[1,0]
    s_waitcnt lgkmcnt(15)
    v_pk_fma_f32 v[96:97], v[180:181], v[172:173], v[96:97] op_sel:[0,1,0] op_sel_hi:[1,1,1]
    v_pk_fma_f32 v[98:99], v[182:183], v[172:173], v[98:99] op_sel:[0,1,0] op_sel_hi:[1,1,1]
    v_pk_fma_f32 v[100:101], v[184:185], v[172:173], v[100:101] op_sel:[0,1,0] op_sel_hi:[1,1,1]
    v_pk_fma_f32 v[102:103], v[186:187], v[172:173], v[102:103] op_sel:[0,1,0] op_sel_hi:[1,1,1]
    v_pk_fma_f32 v[104:105], v[188:189], v[172:173], v[104:105] op_sel:[0,1,0] op_sel_hi:[1,1,1]
    v_pk_fma_f32 v[106:107], v[190:191], v[172:173], v[106:107] op_sel:[0,1,0] op_sel_hi:[1,1,1]
    v_pk_fma_f32 v[108:109], v[192:193], v[172:173], v[108:109] op_sel:[0,1,0] op_sel_hi:[1,1,1]
    v_pk_fma_f32 v[110:111], v[194:195], v[172:173], v[110:111] op_sel:[0,1,0] op_sel_hi:[1,1,1]
    s_waitcnt lgkmcnt(15)
    v_pk_fma_f32 v[96:97], v[196:197], v[174:175], v[96:97] op_sel_hi:[1,0,1]
    v_pk_fma_f32 v[98:99], v[198:199], v[174:175], v[98:99] op_sel_hi:[1,0,1]
    v_pk_fma_f32 v[100:101], v[200:201], v[174:175], v[100:101] op_sel_hi:[1,0,1]
    v_pk_fma_f32 v[102:103], v[202:203], v[174:175], v[102:103] op_sel_hi:[1,0,1]
    v_pk_fma_f32 v[104:105], v[204:205], v[174:175], v[104:105] op_sel_hi:[1,0,1]
    v_pk_fma_f32 v[106:107], v[206:207], v[174:175], v[106:107] op_sel_hi:[1,0,1]
    v_pk_fma_f32 v[108:109], v[208:209], v[174:175], v[108:109] op_sel_hi:[1,0,1]
    v_pk_fma_f32 v[110:111], v[210:211], v[174:175], v[110:111] op_sel_hi:[1,0,1]
    s_waitcnt lgkmcnt(15)
    v_pk_fma_f32 v[96:97], v[212:213], v[174:175], v[96:97] op_sel:[0,1,0] op_sel_hi:[1,1,1]
    v_pk_fma_f32 v[98:99], v[214:215], v[174:175], v[98:99] op_sel:[0,1,0] op_sel_hi:[1,1,1]
    v_pk_fma_f32 v[100:101], v[216:217], v[174:175], v[100:101] op_sel:[0,1,0] op_sel_hi:[1,1,1]
    v_pk_fma_f32 v[102:103], v[218:219], v[174:175], v[102:103] op_sel:[0,1,0] op_sel_hi:[1,1,1]
    v_pk_fma_f32 v[104:105], v[220:221], v[174:175], v[104:105] op_sel:[0,1,0] op_sel_hi:[1,1,1]
    v_pk_fma_f32 v[106:107], v[222:223], v[174:175], v[106:107] op_sel:[0,1,0] op_sel_hi:[1,1,1]
    v_pk_fma_f32 v[108:109], v[224:225], v[174:175], v[108:109] op_sel:[0,1,0] op_sel_hi:[1,1,1]
    v_pk_fma_f32 v[110:111], v[226:227], v[174:175], v[110:111] op_sel:[0,1,0] op_sel_hi:[1,1,1]
    s_waitcnt lgkmcnt(12)
    v_pk_fma_f32 v[96:97], v[64:65], v[176:177], v[96:97] op_sel_hi:[1,0,1]
    v_pk_fma_f32 v[98:99], v[66:67], v[176:177], v[98:99] op_sel_hi:[1,0,1]
    v_pk_fma_f32 v[100:101], v[68:69], v[176:177], v[100:101] op_sel_hi:[1,0,1]
    v_pk_fma_f32 v[102:103], v[70:71], v[176:177], v[102:103] op_sel_hi:[1,0,1]
    v_pk_fma_f32 v[104:105], v[72:73], v[176:177], v[104:105] op_sel_hi:[1,0,1]
    v_pk_fma_f32 v[106:107], v[74:75], v[176:177], v[106:107] op_sel_hi:[1,0,1]
    v_pk_fma_f32 v[108:109], v[76:77], v[176:177], v[108:109] op_sel_hi:[1,0,1]
    v_pk_fma_f32 v[110:111], v[78:79], v[176:177], v[110:111] op_sel_hi:[1,0,1]
    s_waitcnt lgkmcnt(8)
    v_pk_fma_f32 v[96:97], v[80:81], v[176:177], v[96:97] op_sel:[0,1,0] op_sel_hi:[1,1,1]
    v_pk_fma_f32 v[98:99], v[82:83], v[176:177], v[98:99] op_sel:[0,1,0] op_sel_hi:[1,1,1]
    v_pk_fma_f32 v[100:101], v[84:85], v[176:177], v[100:101] op_sel:[0,1,0] op_sel_hi:[1,1,1]
    v_pk_fma_f32 v[102:103], v[86:87], v[176:177], v[102:103] op_sel:[0,1,0] op_sel_hi:[1,1,1]
    v_pk_fma_f32 v[104:105], v[88:89], v[176:177], v[104:105] op_sel:[0,1,0] op_sel_hi:[1,1,1]
    v_pk_fma_f32 v[106:107], v[90:91], v[176:177], v[106:107] op_sel:[0,1,0] op_sel_hi:[1,1,1]
    v_pk_fma_f32 v[108:109], v[92:93], v[176:177], v[108:109] op_sel:[0,1,0] op_sel_hi:[1,1,1]
    v_pk_fma_f32 v[110:111], v[94:95], v[176:177], v[110:111] op_sel:[0,1,0] op_sel_hi:[1,1,1]
    s_waitcnt lgkmcnt(4)
    v_pk_fma_f32 v[96:97], v[116:117], v[178:179], v[96:97] op_sel_hi:[1,0,1]
    v_pk_fma_f32 v[98:99], v[118:119], v[178:179], v[98:99] op_sel_hi:[1,0,1]
    v_pk_fma_f32 v[100:101], v[120:121], v[178:179], v[100:101] op_sel_hi:[1,0,1]
    v_pk_fma_f32 v[102:103], v[122:123], v[178:179], v[102:103] op_sel_hi:[1,0,1]
    v_pk_fma_f32 v[104:105], v[124:125], v[178:179], v[104:105] op_sel_hi:[1,0,1]
    v_pk_fma_f32 v[106:107], v[126:127], v[178:179], v[106:107] op_sel_hi:[1,0,1]
    v_pk_fma_f32 v[108:109], v[128:129], v[178:179], v[108:109] op_sel_hi:[1,0,1]
    v_pk_fma_f32 v[110:111], v[130:131], v[178:179], v[110:111] op_sel_hi:[1,0,1]
    s_waitcnt lgkmcnt(0)
    v_pk_fma_f32 v[96:97], v[132:133], v[178:179], v[96:97] op_sel:[0,1,0] op_sel_hi:[1,1,1]
    v_pk_fma_f32 v[98:99], v[134:135], v[178:179], v[98:99] op_sel:[0,1,0] op_sel_hi:[1,1,1]
    v_pk_fma_f32 v[100:101], v[136:137], v[178:179], v[100:101] op_sel:[0,1,0] op_sel_hi:[1,1,1]
    v_pk_fma_f32 v[102:103], v[138:139], v[178:179], v[102:103] op_sel:[0,1,0] op_sel_hi:[1,1,1]
    v_pk_fma_f32 v[104:105], v[140:141], v[178:179], v[104:105] op_sel:[0,1,0] op_sel_hi:[1,1,1]
    v_pk_fma_f32 v[106:107], v[142:143], v[178:179], v[106:107] op_sel:[0,1,0] op_sel_hi:[1,1,1]
    v_pk_fma_f32 v[108:109], v[144:145], v[178:179], v[108:109] op_sel:[0,1,0] op_sel_hi:[1,1,1]
    v_pk_fma_f32 v[110:111], v[146:147], v[178:179], v[110:111] op_sel:[0,1,0] op_sel_hi:[1,1,1]
    v_cvt_pk_bf16_f32 v40, v96, v97
    v_cvt_pk_bf16_f32 v41, v98, v99
    v_cvt_pk_bf16_f32 v42, v100, v101
    v_cvt_pk_bf16_f32 v43, v102, v103
    v_cvt_pk_bf16_f32 v44, v104, v105
    v_cvt_pk_bf16_f32 v45, v106, v107
    v_cvt_pk_bf16_f32 v46, v108, v109
    v_cvt_pk_bf16_f32 v47, v110, v111
    buffer_store_dwordx4 v[40:43], v253, s[40:43], s58 offen offset:0 sc1
    buffer_store_dwordx4 v[44:47], v253, s[40:43], s58 offen offset:256 sc1
    s_add_u32 s65, s64, s53
    v_mov_b32 v15, s65
    v_lshlrev_b32 v255, 2, v1
    s_waitcnt vmcnt(0)
    s_mov_b32 exec_hi, 0
    buffer_store_dword v15, v255, s[40:43], s62 offen sc1
    s_mov_b32 exec_hi, -1
    s_mov_b32 s56, 4000000
L_lw72:
    ds_read_b32 v15, v10 offset:44
    s_waitcnt lgkmcnt(0)
    v_readfirstlane_b32 s76, v15
    s_nop 0
    s_cmp_ge_u32 s76, s55
    s_cbranch_scc1 L_lwd72
    s_sub_u32 s56, s56, 1
    s_cbranch_scc0 L_lw72
L_lwd72:
    v_subrev_u32 v228, 4096, v247
    v_subrev_u32 v229, 4096, v248
    v_subrev_u32 v230, 4096, v249
    v_subrev_u32 v231, 4096, v250
    ds_read_b64_tr_b16 v[180:181], v228 offset:0
    ds_read_b64_tr_b16 v[182:183], v228 offset:1024
    ds_read_b64_tr_b16 v[184:185], v229 offset:0
    ds_read_b64_tr_b16 v[186:187], v229 offset:1024
    ds_read_b64_tr_b16 v[188:189], v230 offset:0
    ds_read_b64_tr_b16 v[190:191], v230 offset:1024
    ds_read_b64_tr_b16 v[192:193], v231 offset:0
    ds_read_b64_tr_b16 v[194:195], v231 offset:1024
    s_mov_b64 exec, 1
    ds_add_u32 v10, v11 offset:68
    s_mov_b64 exec, -1
    ds_read_b64_tr_b16 v[196:197], v247 offset:0
    ds_read_b64_tr_b16 v[198:199], v247 offset:1024
    ds_read_b64_tr_b16 v[200:201], v248 offset:0
    ds_read_b64_tr_b16 v[202:203], v248 offset:1024
    ds_read_b64_tr_b16 v[204:205], v249 offset:0
    ds_read_b64_tr_b16 v[206:207], v249 offset:1024
    ds_read_b64_tr_b16 v[208:209], v250 offset:0
    ds_read_b64_tr_b16 v[210:211], v250 offset:1024
    s_add_u32 s54, s47, s58
    s_add_u32 s45, s54, 12288
    s_add_u32 s65, s64, s53
    s_mov_b32 s56, 200000
    s_lshl_b64 exec, 1, s81
    s_mov_b32 s76, 0
L_poll_OB:
    buffer_load_dword v15, v245, s[40:43], 0 offen sc1
    s_waitcnt vmcnt(0)
    v_subrev_u32 v15, s65, v15
    v_cmp_le_u32 vcc, 8, v15
    s_nop 1
    s_cbranch_vccnz L_pollmore_OB
    s_cmp_lg_u32 s76, 0
    s_cbranch_scc1 L_polldone_OB
    s_mov_b32 s76, 1
    s_mov_b64 exec, 0xffff
    s_branch L_poll_OB
L_pollmore_OB:
    s_mov_b64 exec, vcc
    s_sub_u32 s56, s56, 1
    s_cbranch_scc0 L_poll_OB
L_polldone_OB:
    s_mov_b64 exec, -1
    buffer_load_dwordx4 v[116:119], v2, s[40:43], s45 offen offset:3072
    buffer_load_dwordx4 v[120:123], v2, s[40:43], s54 offen offset:0
    buffer_load_dwordx4 v[124:127], v2, s[40:43], s54 offen offset:1024
    buffer_load_dwordx4 v[128:131], v2, s[40:43], s54 offen offset:2048
    buffer_load_dwordx4 v[132:135], v2, s[40:43], s54 offen offset:3072
    s_add_u32 s54, s54, 4096
    buffer_load_dwordx4 v[136:139], v2, s[40:43], s54 offen offset:0
    buffer_load_dwordx4 v[140:143], v2, s[40:43], s54 offen offset:1024
    buffer_load_dwordx4 v[144:147], v2, s[40:43], s54 offen offset:2048
    buffer_load_dwordx4 v[148:151], v2, s[40:43], s54 offen offset:3072
    s_add_u32 s54, s54, 4096
    buffer_load_dwordx4 v[152:155], v2, s[40:43], s54 offen offset:0
    buffer_load_dwordx4 v[156:159], v2, s[40:43], s54 offen offset:1024
    buffer_load_dwordx4 v[160:163], v2, s[40:43], s54 offen offset:2048
    buffer_load_dwordx4 v[164:167], v2, s[40:43], s54 offen offset:3072
    s_add_u32 s54, s54, 4096
    buffer_load_dwordx4 v[168:171], v2, s[40:43], s54 offen offset:0
    buffer_load_dwordx4 v[172:175], v2, s[40:43], s54 offen offset:1024
    buffer_load_dwordx4 v[176:179], v2, s[40:43], s54 offen offset:2048
    s_waitcnt vmcnt(15) lgkmcnt(9)
    v_mfma_f32_16x16x32_bf16 v[64:67], v[180:183], v[116:119], 0
    ds_read_b64_tr_b16 v[212:213], v247 offset:4096
    ds_read_b64_tr_b16 v[214:215], v247 offset:5120
    v_mfma_f32_16x16x32_bf16 v[68:71], v[184:187], v[116:119], 0
    ds_read_b64_tr_b16 v[216:217], v248 offset:4096
    ds_read_b64_tr_b16 v[218:219], v248 offset:5120
    v_mfma_f32_16x16x32_bf16 v[72:75], v[188:191], v[116:119], 0
    ds_read_b64_tr_b16 v[220:221], v249 offset:4096
    ds_read_b64_tr_b16 v[222:223], v249 offset:5120
    v_mfma_f32_16x16x32_bf16 v[76:79], v[192:195], v[116:119], 0
    ds_read_b64_tr_b16 v[224:225], v250 offset:4096
    ds_read_b64_tr_b16 v[226:227], v250 offset:5120
    s_waitcnt vmcnt(14) lgkmcnt(8)
    v_mfma_f32_16x16x32_bf16 v[64:67], v[196:199], v[120:123], v[64:67]
    ds_read_b64_tr_b16 v[180:181], v247 offset:8192
    ds_read_b64_tr_b16 v[182:183], v247 offset:9216
    v_mfma_f32_16x16x32_bf16 v[68:71], v[200:203], v[120:123], v[68:71]
    ds_read_b64_tr_b16 v[184:185], v248 offset:8192
    ds_read_b64_tr_b16 v[186:187], v248 offset:9216
    v_mfma_f32_16x16x32_bf16 v[72:75], v[204:207], v[120:123], v[72:75]
    ds_read_b64_tr_b16 v[188:189], v249 offset:8192
    ds_read_b64_tr_b16 v[190:191], v249 offset:9216
    v_mfma_f32_16x16x32_bf16 v[76:79], v[208:211], v[120:123], v[76:79]
    ds_read_b64_tr_b16 v[192:193], v250 offset:8192
    ds_read_b64_tr_b16 v[194:195], v250 offset:9216
    s_waitcnt vmcnt(13) lgkmcnt(8)
    v_mfma_f32_16x16x32_bf16 v[64:67], v[212:215], v[124:127], v[64:67]
    ds_read_b64_tr_b16 v[196:197], v247 offset:12288
    ds_read_b64_tr_b16 v[198:199], v247 offset:13312
    v_mfma_f32_16x16x32_bf16 v[68:71], v[216:219], v[124:127], v[68:71]
    ds_read_b64_tr_b16 v[200:201], v248 offset:12288
    ds_read_b64_tr_b16 v[202:203], v248 offset:13312
    v_mfma_f32_16x16x32_bf16 v[72:75], v[220:223], v[124:127], v[72:75]
    ds_read_b64_tr_b16 v[204:205], v249 offset:12288
    ds_read_b64_tr_b16 v[206:207], v249 offset:13312
    v_mfma_f32_16x16x32_bf16 v[76:79], v[224:227], v[124:127], v[76:79]
    ds_read_b64_tr_b16 v[208:209], v250 offset:12288
    ds_read_b64_tr_b16 v[210:211], v250 offset:13312
    s_waitcnt vmcnt(12) lgkmcnt(8)
    v_mfma_f32_16x16x32_bf16 v[64:67], v[180:183], v[128:131], v[64:67]
    ds_read_b64_tr_b16 v[212:213], v247 offset:16384
    ds_read_b64_tr_b16 v[214:215], v247 offset:17408
    v_mfma_f32_16x16x32_bf16 v[68:71], v[184:187], v[128:131], v[68:71]
    ds_read_b64_tr_b16 v[216:217], v248 offset:16384
    ds_read_b64_tr_b16 v[218:219], v248 offset:17408
    v_mfma_f32_16x16x32_bf16 v[72:75], v[188:191], v[128:131], v[72:75]
    ds_read_b64_tr_b16 v[220:221], v249 offset:16384
    ds_read_b64_tr_b16 v[222:223], v249 offset:17408
    v_mfma_f32_16x16x32_bf16 v[76:79], v[192:195], v[128:131], v[76:79]
    ds_read_b64_tr_b16 v[224:225], v250 offset:16384
    ds_read_b64_tr_b16 v[226:227], v250 offset:17408
    s_waitcnt vmcnt(11) lgkmcnt(8)
    v_mfma_f32_16x16x32_bf16 v[64:67], v[196:199], v[132:135], v[64:67]
    ds_read_b64_tr_b16 v[180:181], v247 offset:20480
    ds_read_b64_tr_b16 v[182:183], v247 offset:21504
    v_mfma_f32_16x16x32_bf16 v[68:71], v[200:203], v[132:135], v[68:71]
    ds_read_b64_tr_b16 v[184:185], v248 offset:20480
    ds_read_b64_tr_b16 v[186:187], v248 offset:21504
    v_mfma_f32_16x16x32_bf16 v[72:75], v[204:207], v[132:135], v[72:75]
    ds_read_b64_tr_b16 v[188:189], v249 offset:20480
    ds_read_b64_tr_b16 v[190:191], v249 offset:21504
    v_mfma_f32_16x16x32_bf16 v[76:79], v[208:211], v[132:135], v[76:79]
    ds_read_b64_tr_b16 v[192:193], v250 offset:20480
    ds_read_b64_tr_b16 v[194:195], v250 offset:21504
    s_waitcnt vmcnt(10) lgkmcnt(8)
    v_mfma_f32_16x16x32_bf16 v[64:67], v[212:215], v[136:139], v[64:67]
    ds_read_b64_tr_b16 v[196:197], v247 offset:24576
    ds_read_b64_tr_b16 v[198:199], v247 offset:25600
    v_mfma_f32_16x16x32_bf16 v[68:71], v[216:219], v[136:139], v[68:71]
    ds_read_b64_tr_b16 v[200:201], v248 offset:24576
    ds_read_b64_tr_b16 v[202:203], v248 offset:25600
    v_mfma_f32_16x16x32_bf16 v[72:75], v[220:223], v[136:139], v[72:75]
    ds_read_b64_tr_b16 v[204:205], v249 offset:24576
    ds_read_b64_tr_b16 v[206:207], v249 offset:25600
    v_mfma_f32_16x16x32_bf16 v[76:79], v[224:227], v[136:139], v[76:79]
    ds_read_b64_tr_b16 v[208:209], v250 offset:24576
    ds_read_b64_tr_b16 v[210:211], v250 offset:25600
    s_waitcnt vmcnt(9) lgkmcnt(8)
    v_mfma_f32_16x16x32_bf16 v[64:67], v[180:183], v[140:143], v[64:67]
    ds_read_b64_tr_b16 v[212:213], v247 offset:28672
    ds_read_b64_tr_b16 v[214:215], v247 offset:29696
    v_mfma_f32_16x16x32_bf16 v[68:71], v[184:187], v[140:143], v[68:71]
    ds_read_b64_tr_b16 v[216:217], v248 offset:28672
    ds_read_b64_tr_b16 v[218:219], v248 offset:29696
    v_mfma_f32_16x16x32_bf16 v[72:75], v[188:191], v[140:143], v[72:75]
    ds_read_b64_tr_b16 v[220:221], v249 offset:28672
    ds_read_b64_tr_b16 v[222:223], v249 offset:29696
    v_mfma_f32_16x16x32_bf16 v[76:79], v[192:195], v[140:143], v[76:79]
    ds_read_b64_tr_b16 v[224:225], v250 offset:28672
    ds_read_b64_tr_b16 v[226:227], v250 offset:29696
    s_waitcnt vmcnt(8) lgkmcnt(8)
    v_mfma_f32_16x16x32_bf16 v[64:67], v[196:199], v[144:147], v[64:67]
    ds_read_b64_tr_b16 v[180:181], v247 offset:32768
    ds_read_b64_tr_b16 v[182:183], v247 offset:33792
    v_mfma_f32_16x16x32_bf16 v[68:71], v[200:203], v[144:147], v[68:71]
    ds_read_b64_tr_b16 v[184:185], v248 offset:32768
    ds_read_b64_tr_b16 v[186:187], v248 offset:33792
    v_mfma_f32_16x16x32_bf16 v[72:75], v[204:207], v[144:147], v[72:75]
    ds_read_b64_tr_b16 v[188:189], v249 offset:32768
    ds_read_b64_tr_b16 v[190:191], v249 offset:33792
    v_mfma_f32_16x16x32_bf16 v[76:79], v[208:211], v[144:147], v[76:79]
    ds_read_b64_tr_b16 v[192:193], v250 offset:32768
    ds_read_b64_tr_b16 v[194:195], v250 offset:33792
    s_waitcnt vmcnt(7) lgkmcnt(8)
    v_mfma_f32_16x16x32_bf16 v[64:67], v[212:215], v[148:151], v[64:67]
    ds_read_b64_tr_b16 v[196:197], v247 offset:36864
    ds_read_b64_tr_b16 v[198:199], v247 offset:37888
    v_mfma_f32_16x16x32_bf16 v[68:71], v[216:219], v[148:151], v[68:71]
    ds_read_b64_tr_b16 v[200:201], v248 offset:36864
    ds_read_b64_tr_b16 v[202:203], v248 offset:37888
    v_mfma_f32_16x16x32_bf16 v[72:75], v[220:223], v[148:151], v[72:75]
    ds_read_b64_tr_b16 v[204:205], v249 offset:36864
    ds_read_b64_tr_b16 v[206:207], v249 offset:37888
    v_mfma_f32_16x16x32_bf16 v[76:79], v[224:227], v[148:151], v[76:79]
    ds_read_b64_tr_b16 v[208:209], v250 offset:36864
    ds_read_b64_tr_b16 v[210:211], v250 offset:37888
    s_waitcnt vmcnt(6) lgkmcnt(8)
    v_mfma_f32_16x16x32_bf16 v[64:67], v[180:183], v[152:155], v[64:67]
    ds_read_b64_tr_b16 v[212:213], v247 offset:40960
    ds_read_b64_tr_b16 v[214:215], v247 offset:41984
    v_mfma_f32_16x16x32_bf16 v[68:71], v[184:187], v[152:155], v[68:71]
    ds_read_b64_tr_b16 v[216:217], v248 offset:40960
    ds_read_b64_tr_b16 v[218:219], v248 offset:41984
    v_mfma_f32_16x16x32_bf16 v[72:75], v[188:191], v[152:155], v[72:75]
    ds_read_b64_tr_b16 v[220:221], v249 offset:40960
    ds_read_b64_tr_b16 v[222:223], v249 offset:41984
    v_mfma_f32_16x16x32_bf16 v[76:79], v[192:195], v[152:155], v[76:79]
    ds_read_b64_tr_b16 v[224:225], v250 offset:40960
    ds_read_b64_tr_b16 v[226:227], v250 offset:41984
    s_waitcnt vmcnt(5) lgkmcnt(8)
    v_mfma_f32_16x16x32_bf16 v[64:67], v[196:199], v[156:159], v[64:67]
    ds_read_b64_tr_b16 v[180:181], v247 offset:45056
    ds_read_b64_tr_b16 v[182:183], v247 offset:46080
    v_mfma_f32_16x16x32_bf16 v[68:71], v[200:203], v[156:159], v[68:71]
    ds_read_b64_tr_b16 v[184:185], v248 offset:45056
    ds_read_b64_tr_b16 v[186:187], v248 offset:46080
    v_mfma_f32_16x16x32_bf16 v[72:75], v[204:207], v[156:159], v[72:75]
    ds_read_b64_tr_b16 v[188:189], v249 offset:45056
    ds_read_b64_tr_b16 v[190:191], v249 offset:46080
    v_mfma_f32_16x16x32_bf16 v[76:79], v[208:211], v[156:159], v[76:79]
    ds_read_b64_tr_b16 v[192:193], v250 offset:45056
    ds_read_b64_tr_b16 v[194:195], v250 offset:46080
    s_waitcnt vmcnt(4) lgkmcnt(8)
    v_mfma_f32_16x16x32_bf16 v[64:67], v[212:215], v[160:163], v[64:67]
    ds_read_b64_tr_b16 v[196:197], v247 offset:49152
    ds_read_b64_tr_b16 v[198:199], v247 offset:50176
    v_mfma_f32_16x16x32_bf16 v[68:71], v[216:219], v[160:163], v[68:71]
    ds_read_b64_tr_b16 v[200:201], v248 offset:49152
    ds_read_b64_tr_b16 v[202:203], v248 offset:50176
    v_mfma_f32_16x16x32_bf16 v[72:75], v[220:223], v[160:163], v[72:75]
    ds_read_b64_tr_b16 v[204:205], v249 offset:49152
    ds_read_b64_tr_b16 v[206:207], v249 offset:50176
    v_mfma_f32_16x16x32_bf16 v[76:79], v[224:227], v[160:163], v[76:79]
    ds_read_b64_tr_b16 v[208:209], v250 offset:49152
    ds_read_b64_tr_b16 v[210:211], v250 offset:50176
    s_waitcnt vmcnt(3) lgkmcnt(8)
    v_mfma_f32_16x16x32_bf16 v[64:67], v[180:183], v[164:167], v[64:67]
    ds_read_b64_tr_b16 v[212:213], v247 offset:53248
    ds_read_b64_tr_b16 v[214:215], v247 offset:54272
    v_mfma_f32_16x16x32_bf16 v[68:71], v[184:187], v[164:167], v[68:71]
    ds_read_b64_tr_b16 v[216:217], v248 offset:53248
    ds_read_b64_tr_b16 v[218:219], v248 offset:54272
    v_mfma_f32_16x16x32_bf16 v[72:75], v[188:191], v[164:167], v[72:75]
    ds_read_b64_tr_b16 v[220:221], v249 offset:53248
    ds_read_b64_tr_b16 v[222:223], v249 offset:54272
    v_mfma_f32_16x16x32_bf16 v[76:79], v[192:195], v[164:167], v[76:79]
    ds_read_b64_tr_b16 v[224:225], v250 offset:53248
    ds_read_b64_tr_b16 v[226:227], v250 offset:54272
    s_waitcnt vmcnt(2) lgkmcnt(8)
    v_mfma_f32_16x16x32_bf16 v[64:67], v[196:199], v[168:171], v[64:67]
    ds_read_b64_tr_b16 v[180:181], v247 offset:57344
    ds_read_b64_tr_b16 v[182:183], v247 offset:58368
    v_mfma_f32_16x16x32_bf16 v[68:71], v[200:203], v[168:171], v[68:71]
    ds_read_b64_tr_b16 v[184:185], v248 offset:57344
    ds_read_b64_tr_b16 v[186:187], v248 offset:58368
    v_mfma_f32_16x16x32_bf16 v[72:75], v[204:207], v[168:171], v[72:75]
    ds_read_b64_tr_b16 v[188:189], v249 offset:57344
    ds_read_b64_tr_b16 v[190:191], v249 offset:58368
    v_mfma_f32_16x16x32_bf16 v[76:79], v[208:211], v[168:171], v[76:79]
    ds_read_b64_tr_b16 v[192:193], v250 offset:57344
    ds_read_b64_tr_b16 v[194:195], v250 offset:58368
    s_waitcnt vmcnt(1) lgkmcnt(8)
    v_mfma_f32_16x16x32_bf16 v[64:67], v[212:215], v[172:175], v[64:67]
    v_mfma_f32_16x16x32_bf16 v[68:71], v[216:219], v[172:175], v[68:71]
    v_mfma_f32_16x16x32_bf16 v[72:75], v[220:223], v[172:175], v[72:75]
    v_mfma_f32_16x16x32_bf16 v[76:79], v[224:227], v[172:175], v[76:79]
    s_waitcnt vmcnt(0) lgkmcnt(0)
    v_mfma_f32_16x16x32_bf16 v[64:67], v[180:183], v[176:179], v[64:67]
    v_mfma_f32_16x16x32_bf16 v[68:71], v[184:187], v[176:179], v[68:71]
    v_mfma_f32_16x16x32_bf16 v[72:75], v[188:191], v[176:179], v[72:75]
    v_mfma_f32_16x16x32_bf16 v[76:79], v[192:195], v[176:179], v[76:79]
    s_nop 4
    v_pk_add_f32 v[64:65], v[64:65], v[16:17]
    v_pk_add_f32 v[66:67], v[66:67], v[18:19]
    v_pk_add_f32 v[68:69], v[68:69], v[20:21]
    v_pk_add_f32 v[70:71], v[70:71], v[22:23]
    v_pk_add_f32 v[72:73], v[72:73], v[24:25]
    v_pk_add_f32 v[74:75], v[74:75], v[26:27]
    v_pk_add_f32 v[76:77], v[76:77], v[28:29]
    v_pk_add_f32 v[78:79], v[78:79], v[30:31]
    v_cvt_pk_bf16_f32 v80, v64, v65
    v_cvt_pk_bf16_f32 v81, v66, v67
    v_cvt_pk_bf16_f32 v82, v68, v69
    v_cvt_pk_bf16_f32 v83, v70, v71
    v_cvt_pk_bf16_f32 v84, v72, v73
    v_cvt_pk_bf16_f32 v85, v74, v75
    v_cvt_pk_bf16_f32 v86, v76, v77
    v_cvt_pk_bf16_f32 v87, v78, v79
    s_cmp_eq_u32 s53, 4
    s_cbranch_scc1 L_final
    buffer_store_dwordx4 v[80:83], v251, s[40:43], s59 offen offset:0 sc1
    buffer_store_dwordx4 v[84:87], v251, s[40:43], s59 offen offset:2048 sc1
    v_lshlrev_b32 v16, 16, v80
    v_and_b32 v17, 0xffff0000, v80
    v_lshlrev_b32 v18, 16, v81
    v_and_b32 v19, 0xffff0000, v81
    v_lshlrev_b32 v20, 16, v82
    v_and_b32 v21, 0xffff0000, v82
    v_lshlrev_b32 v22, 16, v83
    v_and_b32 v23, 0xffff0000, v83
    v_lshlrev_b32 v24, 16, v84
    v_and_b32 v25, 0xffff0000, v84
    v_lshlrev_b32 v26, 16, v85
    v_and_b32 v27, 0xffff0000, v85
    v_lshlrev_b32 v28, 16, v86
    v_and_b32 v29, 0xffff0000, v86
    v_lshlrev_b32 v30, 16, v87
    v_and_b32 v31, 0xffff0000, v87
    v_pk_add_f32 v[116:117], v[16:17], v[18:19]
    v_pk_add_f32 v[118:119], v[20:21], v[22:23]
    v_pk_add_f32 v[120:121], v[24:25], v[26:27]
    v_pk_add_f32 v[122:123], v[28:29], v[30:31]
    v_pk_mul_f32 v[124:125], v[16:17], v[16:17]
    v_pk_mul_f32 v[126:127], v[18:19], v[18:19]
    v_pk_add_f32 v[116:117], v[116:117], v[118:119]
    v_pk_add_f32 v[120:121], v[120:121], v[122:123]
    v_pk_fma_f32 v[124:125], v[20:21], v[20:21], v[124:125]
    v_pk_fma_f32 v[126:127], v[22:23], v[22:23], v[126:127]
    v_pk_fma_f32 v[124:125], v[24:25], v[24:25], v[124:125]
    v_pk_fma_f32 v[126:127], v[26:27], v[26:27], v[126:127]
    v_pk_fma_f32 v[124:125], v[28:29], v[28:29], v[124:125]
    v_pk_fma_f32 v[126:127], v[30:31], v[30:31], v[126:127]
    v_pk_add_f32 v[116:117], v[116:117], v[120:121]
    v_pk_add_f32 v[124:125], v[124:125], v[126:127]
    v_add_f32 v116, v116, v117
    v_add_f32 v124, v124, v125
    s_nop 1
    v_permlane32_swap_b32 v116, v124
    v_add_f32 v116, v116, v124
    v_mov_b32 v124, v116
    s_nop 1
    v_permlane16_swap_b32 v116, v124
    v_add_f32 v116, v116, v124
    s_mov_b32 s100, 0xffff
    s_mov_b32 s101, 0xffff
    s_mov_b64 exec, s[100:101]
    buffer_store_dword v116, v12, s[40:43], s44 offen sc1
    s_mov_b64 exec, -1
    s_add_u32 s65, s64, s53
    v_mov_b32 v15, s65
    v_lshlrev_b32 v255, 2, v1
    s_waitcnt vmcnt(0)
    s_mov_b32 exec_hi, 0
    buffer_store_dword v15, v255, s[40:43], s61 offen sc1
    s_mov_b32 exec_hi, -1
    s_add_u32 s57, s57, 131072
    s_add_u32 s59, s59, 131072
    s_add_u32 s58, s58, 131072
    s_add_u32 s44, s44, 8192
    s_add_u32 s60, s60, 2097152
    s_add_u32 s68, s68, 2097152
    s_add_u32 s46, s46, 4
    s_branch L_A_start
L_final:
    buffer_store_dwordx2 v[80:81], v254, s[32:35], 0 offen offset:0
    buffer_store_dwordx2 v[82:83], v254, s[32:35], 0 offen offset:32
    buffer_store_dwordx2 v[84:85], v254, s[32:35], 0 offen offset:64
    buffer_store_dwordx2 v[86:87], v254, s[32:35], 0 offen offset:96
    s_branch L_end
L_H_loop:
    s_cmp_eq_u32 s52, 0
    s_cbranch_scc1 L_H_first
    s_mov_b32 s56, 4000000
L_lw73:
    ds_read_b32 v8, v10 offset:48
    s_waitcnt lgkmcnt(0)
    v_readfirstlane_b32 s76, v8
    s_nop 0
    s_cmp_ge_u32 s76, s55
    s_cbranch_scc1 L_lwd73
    s_sleep 1
    s_sub_u32 s56, s56, 1
    s_cbranch_scc0 L_lw73
L_lwd73:
    buffer_load_dwordx2 v[248:249], v23, s[40:43], s44 offen offset:0
    buffer_load_dwordx2 v[250:251], v23, s[40:43], s44 offen offset:256
    buffer_load_dwordx2 v[252:253], v23, s[40:43], s44 offen offset:512
    buffer_load_dwordx2 v[254:255], v23, s[40:43], s44 offen offset:768
L_H_first:
    ds_write_b32 v20, v16
    s_cmp_ge_u32 s72, 2
    s_cbranch_scc1 L_csw74
    ds_write_b32 v21, v17
L_csw74:
    s_waitcnt vmcnt(0)
    v_pk_add_f32 v[248:249], v[248:249], v[250:251]
    v_pk_add_f32 v[252:253], v[252:253], v[254:255]
    v_pk_add_f32 v[248:249], v[248:249], v[252:253]
    v_mov_b32 v250, v248
    s_nop 1
    v_permlane32_swap_b32 v248, v250
    v_add_f32 v248, v248, v250
    v_mov_b32 v250, v249
    s_nop 1
    v_permlane32_swap_b32 v249, v250
    v_add_f32 v249, v249, v250
    v_mul_f32 v254, 0xbb000000, v248
    v_mul_f32 v249, 0x3b000000, v249
    v_fma_f32 v250, -v254, v254, v249
    v_max_f32 v250, 0, v250
    v_add_f32 v250, 0x3727c5ac, v250
    v_rsq_f32 v252, v250
    s_nop 0
    v_mul_f32 v253, v254, v252
    v_mul_f32 v255, 0x3fb8aa3b, v252
    ds_write_b128 v25, v[252:255]
    s_mov_b64 exec, 1
    ds_add_u32 v10, v11 offset:32
    s_mov_b64 exec, -1
    s_mov_b32 s56, 4000000
L_lw75:
    ds_read_b32 v8, v10 offset:64
    s_waitcnt lgkmcnt(0)
    v_readfirstlane_b32 s76, v8
    s_nop 0
    s_cmp_ge_u32 s76, s55
    s_cbranch_scc1 L_lwd75
    s_sleep 1
    s_sub_u32 s56, s56, 1
    s_cbranch_scc0 L_lw75
L_lwd75:
    s_cmp_lg_u32 s52, 0
    s_cbranch_scc1 L_H_nowarm
    s_lshr_b32 s73, s2, 3
    s_lshl_b32 s73, s73, 2
    s_add_u32 s73, s73, s72
    s_mul_i32 s54, s73, 4096
    v_lshlrev_b32 v28, 4, v1
    buffer_load_dwordx4 v[160:163], v28, s[20:23], s54 offen offset:0
    buffer_load_dwordx4 v[164:167], v28, s[20:23], s54 offen offset:1024
    buffer_load_dwordx4 v[168:171], v28, s[20:23], s54 offen offset:2048
    buffer_load_dwordx4 v[172:175], v28, s[20:23], s54 offen offset:3072
    s_lshr_b32 s73, s2, 3
    s_lshl_b32 s73, s73, 2
    s_add_u32 s73, s73, s72
    s_mul_i32 s54, s73, 12288
    v_lshlrev_b32 v28, 4, v1
    buffer_load_dwordx4 v[160:163], v28, s[24:27], s54 offen offset:0
    buffer_load_dwordx4 v[164:167], v28, s[24:27], s54 offen offset:1024
    buffer_load_dwordx4 v[168:171], v28, s[24:27], s54 offen offset:2048
    buffer_load_dwordx4 v[172:175], v28, s[24:27], s54 offen offset:3072
    s_add_u32 s54, s54, 4096
    buffer_load_dwordx4 v[160:163], v28, s[24:27], s54 offen offset:0
    buffer_load_dwordx4 v[164:167], v28, s[24:27], s54 offen offset:1024
    buffer_load_dwordx4 v[168:171], v28, s[24:27], s54 offen offset:2048
    buffer_load_dwordx4 v[172:175], v28, s[24:27], s54 offen offset:3072
    s_add_u32 s54, s54, 4096
    buffer_load_dwordx4 v[160:163], v28, s[24:27], s54 offen offset:0
    buffer_load_dwordx4 v[164:167], v28, s[24:27], s54 offen offset:1024
    buffer_load_dwordx4 v[168:171], v28, s[24:27], s54 offen offset:2048
    buffer_load_dwordx4 v[172:175], v28, s[24:27], s54 offen offset:3072
L_H_nowarm:
    s_add_u32 m0, s78, 98304
    s_mov_b32 s54, 0
    buffer_load_dwordx4 v3, s[20:23], s54 offen lds
    s_add_u32 m0, s78, 102400
    s_mov_b32 s54, 32768
    buffer_load_dwordx4 v3, s[20:23], s54 offen lds
    s_add_u32 m0, s78, 106496
    s_mov_b32 s54, 65536
    buffer_load_dwordx4 v3, s[20:23], s54 offen lds
    s_add_u32 m0, s78, 110592
    s_mov_b32 s54, 98304
    buffer_load_dwordx4 v3, s[20:23], s54 offen lds
    s_add_u32 m0, s78, 114688
    s_mov_b32 s54, 131072
    buffer_load_dwordx4 v3, s[20:23], s54 offen lds
    s_add_u32 m0, s78, 118784
    s_mov_b32 s54, 163840
    buffer_load_dwordx4 v3, s[20:23], s54 offen lds
    s_add_u32 m0, s78, 122880
    s_mov_b32 s54, 196608
    buffer_load_dwordx4 v3, s[20:23], s54 offen lds
    s_add_u32 m0, s78, 126976
    s_mov_b32 s54, 229376
    buffer_load_dwordx4 v3, s[20:23], s54 offen lds
    s_add_u32 m0, s78, 131072
    s_mov_b32 s54, 262144
    buffer_load_dwordx4 v3, s[20:23], s54 offen lds
    s_add_u32 m0, s78, 135168
    s_mov_b32 s54, 294912
    buffer_load_dwordx4 v3, s[20:23], s54 offen lds
    s_add_u32 m0, s78, 139264
    s_mov_b32 s54, 327680
    buffer_load_dwordx4 v3, s[20:23], s54 offen lds
    s_add_u32 m0, s78, 143360
    s_mov_b32 s54, 360448
    buffer_load_dwordx4 v3, s[20:23], s54 offen lds
    s_add_u32 m0, s78, 147456
    s_mov_b32 s54, 393216
    buffer_load_dwordx4 v3, s[20:23], s54 offen lds
    s_add_u32 m0, s78, 151552
    s_mov_b32 s54, 425984
    buffer_load_dwordx4 v3, s[20:23], s54 offen lds
    s_add_u32 m0, s78, 155648
    s_mov_b32 s54, 458752
    buffer_load_dwordx4 v3, s[20:23], s54 offen lds
    s_cmp_lg_u32 s52, 0
    s_cbranch_scc1 L_H_nopark
    s_mov_b32 s54, 0
    buffer_load_dwordx4 v[128:131], v2, s[24:27], s54 offen
    s_mov_b32 s54, 1024
    buffer_load_dwordx4 v[132:135], v2, s[24:27], s54 offen
    s_mov_b32 s54, 2048
    buffer_load_dwordx4 v[136:139], v2, s[24:27], s54 offen
    s_mov_b32 s54, 196608
    buffer_load_dwordx4 v[140:143], v2, s[24:27], s54 offen
    s_mov_b32 s54, 197632
    buffer_load_dwordx4 v[144:147], v2, s[24:27], s54 offen
    s_mov_b32 s54, 198656
    buffer_load_dwordx4 v[148:151], v2, s[24:27], s54 offen
    s_mov_b32 s54, 393216
    buffer_load_dwordx4 v[152:155], v2, s[24:27], s54 offen
    s_mov_b32 s54, 394240
    buffer_load_dwordx4 v[156:159], v2, s[24:27], s54 offen
    s_mov_b32 s54, 395264
    buffer_load_dwordx4 v[160:163], v2, s[24:27], s54 offen
    s_mov_b32 s54, 589824
    buffer_load_dwordx4 v[164:167], v2, s[24:27], s54 offen
    s_mov_b32 s54, 590848
    buffer_load_dwordx4 v[168:171], v2, s[24:27], s54 offen
    s_mov_b32 s54, 591872
    buffer_load_dwordx4 v[172:175], v2, s[24:27], s54 offen
    s_mov_b32 s54, 786432
    buffer_load_dwordx4 v[176:179], v2, s[24:27], s54 offen
    s_mov_b32 s54, 787456
    buffer_load_dwordx4 v[180:183], v2, s[24:27], s54 offen
    s_mov_b32 s54, 788480
    buffer_load_dwordx4 v[184:187], v2, s[24:27], s54 offen
    s_mov_b32 s54, 983040
    buffer_load_dwordx4 v[188:191], v2, s[24:27], s54 offen
    s_mov_b32 s54, 984064
    buffer_load_dwordx4 v[192:195], v2, s[24:27], s54 offen
    s_mov_b32 s54, 985088
    buffer_load_dwordx4 v[196:199], v2, s[24:27], s54 offen
    s_mov_b32 s54, 1179648
    buffer_load_dwordx4 v[200:203], v2, s[24:27], s54 offen
    s_mov_b32 s54, 1180672
    buffer_load_dwordx4 v[204:207], v2, s[24:27], s54 offen
    s_mov_b32 s54, 1181696
    buffer_load_dwordx4 v[208:211], v2, s[24:27], s54 offen
    s_mov_b32 s54, 1376256
    buffer_load_dwordx4 v[212:215], v2, s[24:27], s54 offen
    s_mov_b32 s54, 1377280
    buffer_load_dwordx4 v[216:219], v2, s[24:27], s54 offen
    s_mov_b32 s54, 1378304
    buffer_load_dwordx4 v[220:223], v2, s[24:27], s54 offen
L_H_nopark:
    s_mov_b32 s56, 4000000
L_lw76:
    ds_read_b32 v8, v10 offset:60
    s_waitcnt lgkmcnt(0)
    v_readfirstlane_b32 s76, v8
    s_nop 0
    s_cmp_ge_u32 s76, s46
    s_cbranch_scc1 L_lwd76
    s_sleep 1
    s_sub_u32 s56, s56, 1
    s_cbranch_scc0 L_lw76
L_lwd76:
    s_add_u32 m0, s78, 86016
    s_mov_b32 s54, 491520
    buffer_load_dwordx4 v3, s[20:23], s54 offen lds
    s_waitcnt vmcnt(0)
    s_mov_b64 exec, 1
    ds_add_u32 v10, v11 offset:44
    s_mov_b64 exec, -1
    s_cmp_lg_u32 s52, 0
    s_cbranch_scc1 L_H_nopark2
    s_waitcnt vmcnt(0)
L_H_nopark2:
    s_mov_b32 s56, 4000000
L_lw77:
    ds_read_b32 v8, v10 offset:52
    s_waitcnt lgkmcnt(0)
    v_readfirstlane_b32 s76, v8
    s_nop 0
    s_cmp_ge_u32 s76, s55
    s_cbranch_scc1 L_lwd77
    s_sleep 1
    s_sub_u32 s56, s56, 1
    s_cbranch_scc0 L_lw77
L_lwd77:
    ds_write_b128 v27, v[128:131] offset:0
    ds_write_b128 v27, v[132:135] offset:4096
    ds_write_b128 v27, v[136:139] offset:8192
    s_mov_b64 exec, 1
    ds_add_u32 v10, v11 offset:0
    s_mov_b64 exec, -1
    ds_write_b128 v27, v[140:143] offset:12288
    ds_write_b128 v27, v[144:147] offset:16384
    ds_write_b128 v27, v[148:151] offset:20480
    s_mov_b64 exec, 1
    ds_add_u32 v10, v11 offset:4
    s_mov_b64 exec, -1
    ds_write_b128 v27, v[152:155] offset:24576
    ds_write_b128 v27, v[156:159] offset:28672
    ds_write_b128 v27, v[160:163] offset:32768
    s_mov_b64 exec, 1
    ds_add_u32 v10, v11 offset:8
    s_mov_b64 exec, -1
    ds_write_b128 v27, v[164:167] offset:36864
    ds_write_b128 v27, v[168:171] offset:40960
    ds_write_b128 v27, v[172:175] offset:45056
    s_mov_b64 exec, 1
    ds_add_u32 v10, v11 offset:12
    s_mov_b64 exec, -1
    ds_write_b128 v27, v[176:179] offset:49152
    ds_write_b128 v27, v[180:183] offset:53248
    ds_write_b128 v27, v[184:187] offset:57344
    s_mov_b64 exec, 1
    ds_add_u32 v10, v11 offset:16
    s_mov_b64 exec, -1
    s_mov_b32 s56, 4000000
L_lw78:
    ds_read_b32 v8, v10 offset:68
    s_waitcnt lgkmcnt(0)
    v_readfirstlane_b32 s76, v8
    s_nop 0
    s_cmp_ge_u32 s76, s55
    s_cbranch_scc1 L_lwd78
    s_sleep 1
    s_sub_u32 s56, s56, 1
    s_cbranch_scc0 L_lw78
L_lwd78:
    ds_write_b128 v9, v[188:191] offset:0
    ds_write_b128 v9, v[192:195] offset:4096
    ds_write_b128 v9, v[196:199] offset:8192
    s_mov_b64 exec, 1
    ds_add_u32 v10, v11 offset:20
    s_mov_b64 exec, -1
    ds_write_b128 v9, v[200:203] offset:12288
    ds_write_b128 v9, v[204:207] offset:16384
    ds_write_b128 v9, v[208:211] offset:20480
    s_mov_b64 exec, 1
    ds_add_u32 v10, v11 offset:24
    s_mov_b64 exec, -1
    ds_write_b128 v9, v[212:215] offset:24576
    ds_write_b128 v9, v[216:219] offset:28672
    ds_write_b128 v9, v[220:223] offset:32768
    s_mov_b64 exec, 1
    ds_add_u32 v10, v11 offset:28
    s_mov_b64 exec, -1
    s_add_u32 s53, s53, 1
    s_add_u32 s55, s55, 4
    s_add_u32 s44, s44, 8192
    s_cmp_lg_u32 s52, 0
    s_cbranch_scc1 L_H_nocs
    s_mov_b32 s56, 4000000
L_lw79:
    ds_read_b32 v8, v10 offset:0
    s_waitcnt lgkmcnt(0)
    v_readfirstlane_b32 s76, v8
    s_nop 0
    s_cmp_ge_u32 s76, s55
    s_cbranch_scc1 L_lwd79
    s_sleep 1
    s_sub_u32 s56, s56, 1
    s_cbranch_scc0 L_lw79
L_lwd79:
    ds_read_b64_tr_b16 v[224:225], v4 offset:0
    ds_read_b64_tr_b16 v[226:227], v4 offset:256
    ds_read_b64_tr_b16 v[228:229], v4 offset:2048
    ds_read_b64_tr_b16 v[230:231], v4 offset:2304
    s_waitcnt lgkmcnt(2)
    v_mfma_f32_16x16x32_bf16 v[240:243], v[12:15], v[224:227], 0
    s_waitcnt lgkmcnt(0)
    v_mfma_f32_16x16x32_bf16 v[240:243], v[12:15], v[228:231], v[240:243]
    s_cmp_ge_u32 s72, 2
    s_cbranch_scc1 L_cs80
    ds_read_b64_tr_b16 v[232:233], v6 offset:0
    ds_read_b64_tr_b16 v[234:235], v6 offset:256
    ds_read_b64_tr_b16 v[236:237], v6 offset:2048
    ds_read_b64_tr_b16 v[238:239], v6 offset:2304
    s_waitcnt lgkmcnt(2)
    v_mfma_f32_16x16x32_bf16 v[244:247], v[12:15], v[232:235], 0
    s_waitcnt lgkmcnt(0)
    v_mfma_f32_16x16x32_bf16 v[244:247], v[12:15], v[236:239], v[244:247]
L_cs80:
    s_mov_b32 s56, 4000000
L_lw81:
    ds_read_b32 v8, v10 offset:4
    s_waitcnt lgkmcnt(0)
    v_readfirstlane_b32 s76, v8
    s_nop 0
    s_cmp_ge_u32 s76, s55
    s_cbranch_scc1 L_lwd81
    s_sleep 1
    s_sub_u32 s56, s56, 1
    s_cbranch_scc0 L_lw81
L_lwd81:
    ds_read_b64_tr_b16 v[224:225], v4 offset:12288
    ds_read_b64_tr_b16 v[226:227], v4 offset:12544
    ds_read_b64_tr_b16 v[228:229], v4 offset:14336
    ds_read_b64_tr_b16 v[230:231], v4 offset:14592
    s_waitcnt lgkmcnt(2)
    v_mfma_f32_16x16x32_bf16 v[240:243], v[12:15], v[224:227], v[240:243]
    s_waitcnt lgkmcnt(0)
    v_mfma_f32_16x16x32_bf16 v[240:243], v[12:15], v[228:231], v[240:243]
    s_cmp_ge_u32 s72, 2
    s_cbranch_scc1 L_cs82
    ds_read_b64_tr_b16 v[232:233], v6 offset:12288
    ds_read_b64_tr_b16 v[234:235], v6 offset:12544
    ds_read_b64_tr_b16 v[236:237], v6 offset:14336
    ds_read_b64_tr_b16 v[238:239], v6 offset:14592
    s_waitcnt lgkmcnt(2)
    v_mfma_f32_16x16x32_bf16 v[244:247], v[12:15], v[232:235], v[244:247]
    s_waitcnt lgkmcnt(0)
    v_mfma_f32_16x16x32_bf16 v[244:247], v[12:15], v[236:239], v[244:247]
L_cs82:
    s_mov_b32 s56, 4000000
L_lw83:
    ds_read_b32 v8, v10 offset:8
    s_waitcnt lgkmcnt(0)
    v_readfirstlane_b32 s76, v8
    s_nop 0
    s_cmp_ge_u32 s76, s55
    s_cbranch_scc1 L_lwd83
    s_sleep 1
    s_sub_u32 s56, s56, 1
    s_cbranch_scc0 L_lw83
L_lwd83:
    ds_read_b64_tr_b16 v[224:225], v4 offset:24576
    ds_read_b64_tr_b16 v[226:227], v4 offset:24832
    ds_read_b64_tr_b16 v[228:229], v4 offset:26624
    ds_read_b64_tr_b16 v[230:231], v4 offset:26880
    s_waitcnt lgkmcnt(2)
    v_mfma_f32_16x16x32_bf16 v[240:243], v[12:15], v[224:227], v[240:243]
    s_waitcnt lgkmcnt(0)
    v_mfma_f32_16x16x32_bf16 v[240:243], v[12:15], v[228:231], v[240:243]
    s_cmp_ge_u32 s72, 2
    s_cbranch_scc1 L_cs84
    ds_read_b64_tr_b16 v[232:233], v6 offset:24576
    ds_read_b64_tr_b16 v[234:235], v6 offset:24832
    ds_read_b64_tr_b16 v[236:237], v6 offset:26624
    ds_read_b64_tr_b16 v[238:239], v6 offset:26880
    s_waitcnt lgkmcnt(2)
    v_mfma_f32_16x16x32_bf16 v[244:247], v[12:15], v[232:235], v[244:247]
    s_waitcnt lgkmcnt(0)
    v_mfma_f32_16x16x32_bf16 v[244:247], v[12:15], v[236:239], v[244:247]
L_cs84:
    s_mov_b32 s56, 4000000
L_lw85:
    ds_read_b32 v8, v10 offset:12
    s_waitcnt lgkmcnt(0)
    v_readfirstlane_b32 s76, v8
    s_nop 0
    s_cmp_ge_u32 s76, s55
    s_cbranch_scc1 L_lwd85
    s_sleep 1
    s_sub_u32 s56, s56, 1
    s_cbranch_scc0 L_lw85
L_lwd85:
    ds_read_b64_tr_b16 v[224:225], v4 offset:36864
    ds_read_b64_tr_b16 v[226:227], v4 offset:37120
    ds_read_b64_tr_b16 v[228:229], v4 offset:38912
    ds_read_b64_tr_b16 v[230:231], v4 offset:39168
    s_waitcnt lgkmcnt(2)
    v_mfma_f32_16x16x32_bf16 v[240:243], v[12:15], v[224:227], v[240:243]
    s_waitcnt lgkmcnt(0)
    v_mfma_f32_16x16x32_bf16 v[240:243], v[12:15], v[228:231], v[240:243]
    s_cmp_ge_u32 s72, 2
    s_cbranch_scc1 L_cs86
    ds_read_b64_tr_b16 v[232:233], v6 offset:36864
    ds_read_b64_tr_b16 v[234:235], v6 offset:37120
    ds_read_b64_tr_b16 v[236:237], v6 offset:38912
    ds_read_b64_tr_b16 v[238:239], v6 offset:39168
    s_waitcnt lgkmcnt(2)
    v_mfma_f32_16x16x32_bf16 v[244:247], v[12:15], v[232:235], v[244:247]
    s_waitcnt lgkmcnt(0)
    v_mfma_f32_16x16x32_bf16 v[244:247], v[12:15], v[236:239], v[244:247]
L_cs86:
    s_mov_b32 s56, 4000000
L_lw87:
    ds_read_b32 v8, v10 offset:16
    s_waitcnt lgkmcnt(0)
    v_readfirstlane_b32 s76, v8
    s_nop 0
    s_cmp_ge_u32 s76, s55
    s_cbranch_scc1 L_lwd87
    s_sleep 1
    s_sub_u32 s56, s56, 1
    s_cbranch_scc0 L_lw87
L_lwd87:
    ds_read_b64_tr_b16 v[224:225], v4 offset:49152
    ds_read_b64_tr_b16 v[226:227], v4 offset:49408
    ds_read_b64_tr_b16 v[228:229], v4 offset:51200
    ds_read_b64_tr_b16 v[230:231], v4 offset:51456
    s_waitcnt lgkmcnt(2)
    v_mfma_f32_16x16x32_bf16 v[240:243], v[12:15], v[224:227], v[240:243]
    s_waitcnt lgkmcnt(0)
    v_mfma_f32_16x16x32_bf16 v[240:243], v[12:15], v[228:231], v[240:243]
    s_cmp_ge_u32 s72, 2
    s_cbranch_scc1 L_cs88
    ds_read_b64_tr_b16 v[232:233], v6 offset:49152
    ds_read_b64_tr_b16 v[234:235], v6 offset:49408
    ds_read_b64_tr_b16 v[236:237], v6 offset:51200
    ds_read_b64_tr_b16 v[238:239], v6 offset:51456
    s_waitcnt lgkmcnt(2)
    v_mfma_f32_16x16x32_bf16 v[244:247], v[12:15], v[232:235], v[244:247]
    s_waitcnt lgkmcnt(0)
    v_mfma_f32_16x16x32_bf16 v[244:247], v[12:15], v[236:239], v[244:247]
L_cs88:
    s_mov_b32 s56, 4000000
L_lw89:
    ds_read_b32 v8, v10 offset:20
    s_waitcnt lgkmcnt(0)
    v_readfirstlane_b32 s76, v8
    s_nop 0
    s_cmp_ge_u32 s76, s55
    s_cbranch_scc1 L_lwd89
    s_sleep 1
    s_sub_u32 s56, s56, 1
    s_cbranch_scc0 L_lw89
L_lwd89:
    ds_read_b64_tr_b16 v[224:225], v5 offset:0
    ds_read_b64_tr_b16 v[226:227], v5 offset:256
    ds_read_b64_tr_b16 v[228:229], v5 offset:2048
    ds_read_b64_tr_b16 v[230:231], v5 offset:2304
    s_waitcnt lgkmcnt(2)
    v_mfma_f32_16x16x32_bf16 v[240:243], v[12:15], v[224:227], v[240:243]
    s_waitcnt lgkmcnt(0)
    v_mfma_f32_16x16x32_bf16 v[240:243], v[12:15], v[228:231], v[240:243]
    s_cmp_ge_u32 s72, 2
    s_cbranch_scc1 L_cs90
    ds_read_b64_tr_b16 v[232:233], v7 offset:0
    ds_read_b64_tr_b16 v[234:235], v7 offset:256
    ds_read_b64_tr_b16 v[236:237], v7 offset:2048
    ds_read_b64_tr_b16 v[238:239], v7 offset:2304
    s_waitcnt lgkmcnt(2)
    v_mfma_f32_16x16x32_bf16 v[244:247], v[12:15], v[232:235], v[244:247]
    s_waitcnt lgkmcnt(0)
    v_mfma_f32_16x16x32_bf16 v[244:247], v[12:15], v[236:239], v[244:247]
L_cs90:
    s_mov_b32 s56, 4000000
L_lw91:
    ds_read_b32 v8, v10 offset:24
    s_waitcnt lgkmcnt(0)
    v_readfirstlane_b32 s76, v8
    s_nop 0
    s_cmp_ge_u32 s76, s55
    s_cbranch_scc1 L_lwd91
    s_sleep 1
    s_sub_u32 s56, s56, 1
    s_cbranch_scc0 L_lw91
L_lwd91:
    ds_read_b64_tr_b16 v[224:225], v5 offset:12288
    ds_read_b64_tr_b16 v[226:227], v5 offset:12544
    ds_read_b64_tr_b16 v[228:229], v5 offset:14336
    ds_read_b64_tr_b16 v[230:231], v5 offset:14592
    s_waitcnt lgkmcnt(2)
    v_mfma_f32_16x16x32_bf16 v[240:243], v[12:15], v[224:227], v[240:243]
    s_waitcnt lgkmcnt(0)
    v_mfma_f32_16x16x32_bf16 v[240:243], v[12:15], v[228:231], v[240:243]
    s_cmp_ge_u32 s72, 2
    s_cbranch_scc1 L_cs92
    ds_read_b64_tr_b16 v[232:233], v7 offset:12288
    ds_read_b64_tr_b16 v[234:235], v7 offset:12544
    ds_read_b64_tr_b16 v[236:237], v7 offset:14336
    ds_read_b64_tr_b16 v[238:239], v7 offset:14592
    s_waitcnt lgkmcnt(2)
    v_mfma_f32_16x16x32_bf16 v[244:247], v[12:15], v[232:235], v[244:247]
    s_waitcnt lgkmcnt(0)
    v_mfma_f32_16x16x32_bf16 v[244:247], v[12:15], v[236:239], v[244:247]
L_cs92:
    s_mov_b32 s56, 4000000
L_lw93:
    ds_read_b32 v8, v10 offset:28
    s_waitcnt lgkmcnt(0)
    v_readfirstlane_b32 s76, v8
    s_nop 0
    s_cmp_ge_u32 s76, s55
    s_cbranch_scc1 L_lwd93
    s_sleep 1
    s_sub_u32 s56, s56, 1
    s_cbranch_scc0 L_lw93
L_lwd93:
    ds_read_b64_tr_b16 v[224:225], v5 offset:24576
    ds_read_b64_tr_b16 v[226:227], v5 offset:24832
    ds_read_b64_tr_b16 v[228:229], v5 offset:26624
    ds_read_b64_tr_b16 v[230:231], v5 offset:26880
    s_waitcnt lgkmcnt(2)
    v_mfma_f32_16x16x32_bf16 v[240:243], v[12:15], v[224:227], v[240:243]
    s_waitcnt lgkmcnt(0)
    v_mfma_f32_16x16x32_bf16 v[240:243], v[12:15], v[228:231], v[240:243]
    s_cmp_ge_u32 s72, 2
    s_cbranch_scc1 L_cs94
    ds_read_b64_tr_b16 v[232:233], v7 offset:24576
    ds_read_b64_tr_b16 v[234:235], v7 offset:24832
    ds_read_b64_tr_b16 v[236:237], v7 offset:26624
    ds_read_b64_tr_b16 v[238:239], v7 offset:26880
    s_waitcnt lgkmcnt(2)
    v_mfma_f32_16x16x32_bf16 v[244:247], v[12:15], v[232:235], v[244:247]
    s_waitcnt lgkmcnt(0)
    v_mfma_f32_16x16x32_bf16 v[244:247], v[12:15], v[236:239], v[244:247]
L_cs94:
    s_nop 7
    s_nop 1
    v_mov_b32 v18, v240
    v_mov_b32 v19, v244
L_H_nocs:
    s_cmp_lg_u32 s72, 0
    s_cbranch_scc1 L_H_nohalo
    s_cmp_lg_u32 s52, 0
    s_cbranch_scc1 L_H_gotnon
    s_sub_u32 s73, s4, 1
    s_max_i32 s73, s73, 0
    s_lshl_b32 s73, s73, 4
    s_mov_b32 s56, 200000
L_H_non:
    buffer_load_dword v8, off, s[36:39], s73 sc1
    s_waitcnt vmcnt(0)
    v_readfirstlane_b32 s66, v8
    s_nop 0
    s_cmp_lg_u32 s66, 0
    s_cbranch_scc1 L_H_gotnon
    s_sub_u32 s56, s56, 1
    s_cbranch_scc0 L_H_non
L_H_gotnon:
    s_sub_u32 s45, s53, 1
    s_add_u32 s65, s45, s66
    s_mov_b32 s56, 200000
    s_lshl_b64 exec, 1, s7
    s_mov_b32 s76, 0
L_poll_H:
    buffer_load_dword v8, v22, s[40:43], 0 offen sc1
    s_waitcnt vmcnt(0)
    v_subrev_u32 v8, s65, v8
    v_cmp_le_u32 vcc, 8, v8
    s_nop 1
    s_cbranch_vccnz L_pollmore_H
    s_cmp_lg_u32 s76, 0
    s_cbranch_scc1 L_polldone_H
    s_mov_b32 s76, 1
    s_mov_b64 exec, 0xff
    s_branch L_poll_H
L_pollmore_H:
    s_mov_b64 exec, vcc
    s_sub_u32 s56, s56, 1
    s_cbranch_scc0 L_poll_H
L_polldone_H:
    s_mov_b64 exec, -1
    v_mov_b32 v8, s53
    s_mov_b64 exec, 1
    ds_write_b32 v10, v8 offset:72
    s_mov_b64 exec, -1
    buffer_load_dwordx2 v[224:225], v24, s[40:43], s44 offen offset:0
    buffer_load_dwordx2 v[226:227], v24, s[40:43], s44 offen offset:256
    buffer_load_dwordx2 v[228:229], v24, s[40:43], s44 offen offset:512
    buffer_load_dwordx2 v[230:231], v24, s[40:43], s44 offen offset:768
    s_mov_b32 s56, 4000000
L_lw95:
    ds_read_b32 v8, v10 offset:48
    s_waitcnt lgkmcnt(0)
    v_readfirstlane_b32 s76, v8
    s_nop 0
    s_cmp_ge_u32 s76, s55
    s_cbranch_scc1 L_lwd95
    s_sleep 1
    s_sub_u32 s56, s56, 1
    s_cbranch_scc0 L_lw95
L_lwd95:
    s_waitcnt vmcnt(0)
    v_pk_add_f32 v[224:225], v[224:225], v[226:227]
    v_pk_add_f32 v[228:229], v[228:229], v[230:231]
    v_pk_add_f32 v[224:225], v[224:225], v[228:229]
    v_mov_b32 v226, v224
    s_nop 1
    v_permlane32_swap_b32 v224, v226
    v_add_f32 v224, v224, v226
    v_mov_b32 v226, v225
    s_nop 1
    v_permlane32_swap_b32 v225, v226
    v_add_f32 v225, v225, v226
    v_mul_f32 v230, 0xbb000000, v224
    v_mul_f32 v225, 0x3b000000, v225
    v_fma_f32 v226, -v230, v230, v225
    v_max_f32 v226, 0, v226
    v_add_f32 v226, 0x3727c5ac, v226
    v_rsq_f32 v228, v226
    s_nop 0
    v_mul_f32 v229, v230, v228
    v_mul_f32 v231, 0x3fb8aa3b, v228
    ds_write_b128 v26, v[228:231]
L_H_nohalo:
    s_mov_b32 s56, 4000000
L_lw96:
    ds_read_b32 v8, v10 offset:48
    s_waitcnt lgkmcnt(0)
    v_readfirstlane_b32 s76, v8
    s_nop 0
    s_cmp_ge_u32 s76, s55
    s_cbranch_scc1 L_lwd96
    s_sleep 1
    s_sub_u32 s56, s56, 1
    s_cbranch_scc0 L_lw96
L_lwd96:
    buffer_load_dwordx2 v[248:249], v23, s[40:43], s44 offen offset:0
    buffer_load_dwordx2 v[250:251], v23, s[40:43], s44 offen offset:256
    buffer_load_dwordx2 v[252:253], v23, s[40:43], s44 offen offset:512
    buffer_load_dwordx2 v[254:255], v23, s[40:43], s44 offen offset:768
    ds_write_b32 v20, v18
    s_cmp_ge_u32 s72, 2
    s_cbranch_scc1 L_csw97
    ds_write_b32 v21, v19
L_csw97:
    s_waitcnt vmcnt(0)
    v_pk_add_f32 v[248:249], v[248:249], v[250:251]
    v_pk_add_f32 v[252:253], v[252:253], v[254:255]
    v_pk_add_f32 v[248:249], v[248:249], v[252:253]
    v_mov_b32 v250, v248
    s_nop 1
    v_permlane32_swap_b32 v248, v250
    v_add_f32 v248, v248, v250
    v_mov_b32 v250, v249
    s_nop 1
    v_permlane32_swap_b32 v249, v250
    v_add_f32 v249, v249, v250
    v_mul_f32 v254, 0xbb000000, v248
    v_mul_f32 v249, 0x3b000000, v249
    v_fma_f32 v250, -v254, v254, v249
    v_max_f32 v250, 0, v250
    v_add_f32 v250, 0x3727c5ac, v250
    v_rsq_f32 v252, v250
    s_nop 0
    v_mul_f32 v253, v254, v252
    v_mul_f32 v255, 0x3fb8aa3b, v252
    ds_write_b128 v25, v[252:255]
    s_mov_b64 exec, 1
    ds_add_u32 v10, v11 offset:32
    s_mov_b64 exec, -1
    s_mov_b32 s56, 4000000
L_lw98:
    ds_read_b32 v8, v10 offset:64
    s_waitcnt lgkmcnt(0)
    v_readfirstlane_b32 s76, v8
    s_nop 0
    s_cmp_ge_u32 s76, s55
    s_cbranch_scc1 L_lwd98
    s_sleep 1
    s_sub_u32 s56, s56, 1
    s_cbranch_scc0 L_lw98
L_lwd98:
    s_add_u32 m0, s78, 98304
    s_mov_b32 s54, 0
    buffer_load_dwordx4 v3, s[28:31], s54 offen lds
    s_add_u32 m0, s78, 102400
    s_mov_b32 s54, 32768
    buffer_load_dwordx4 v3, s[28:31], s54 offen lds
    s_add_u32 m0, s78, 106496
    s_mov_b32 s54, 65536
    buffer_load_dwordx4 v3, s[28:31], s54 offen lds
    s_add_u32 m0, s78, 110592
    s_mov_b32 s54, 98304
    buffer_load_dwordx4 v3, s[28:31], s54 offen lds
    s_add_u32 m0, s78, 114688
    s_mov_b32 s54, 131072
    buffer_load_dwordx4 v3, s[28:31], s54 offen lds
    s_add_u32 m0, s78, 118784
    s_mov_b32 s54, 163840
    buffer_load_dwordx4 v3, s[28:31], s54 offen lds
    s_add_u32 m0, s78, 122880
    s_mov_b32 s54, 196608
    buffer_load_dwordx4 v3, s[28:31], s54 offen lds
    s_add_u32 m0, s78, 126976
    s_mov_b32 s54, 229376
    buffer_load_dwordx4 v3, s[28:31], s54 offen lds
    s_add_u32 m0, s78, 131072
    s_mov_b32 s54, 262144
    buffer_load_dwordx4 v3, s[28:31], s54 offen lds
    s_add_u32 m0, s78, 135168
    s_mov_b32 s54, 294912
    buffer_load_dwordx4 v3, s[28:31], s54 offen lds
    s_add_u32 m0, s78, 139264
    s_mov_b32 s54, 327680
    buffer_load_dwordx4 v3, s[28:31], s54 offen lds
    s_add_u32 m0, s78, 143360
    s_mov_b32 s54, 360448
    buffer_load_dwordx4 v3, s[28:31], s54 offen lds
    s_add_u32 m0, s78, 147456
    s_mov_b32 s54, 393216
    buffer_load_dwordx4 v3, s[28:31], s54 offen lds
    s_add_u32 m0, s78, 151552
    s_mov_b32 s54, 425984
    buffer_load_dwordx4 v3, s[28:31], s54 offen lds
    s_add_u32 m0, s78, 155648
    s_mov_b32 s54, 458752
    buffer_load_dwordx4 v3, s[28:31], s54 offen lds
    s_mov_b32 s56, 4000000
L_lw99:
    ds_read_b32 v8, v10 offset:36
    s_waitcnt lgkmcnt(0)
    v_readfirstlane_b32 s76, v8
    s_nop 0
    s_cmp_ge_u32 s76, s55
    s_cbranch_scc1 L_lwd99
    s_sleep 1
    s_sub_u32 s56, s56, 1
    s_cbranch_scc0 L_lw99
L_lwd99:
    s_add_u32 m0, s78, 94208
    s_mov_b32 s54, 491520
    buffer_load_dwordx4 v3, s[28:31], s54 offen lds
    s_waitcnt vmcnt(0)
    s_mov_b64 exec, 1
    ds_add_u32 v10, v11 offset:44
    s_mov_b64 exec, -1
    s_cmp_lg_u32 s52, 0
    s_cbranch_scc1 L_H_last
    s_mov_b32 s56, 4000000
L_lw100:
    ds_read_b32 v8, v10 offset:52
    s_waitcnt lgkmcnt(0)
    v_readfirstlane_b32 s76, v8
    s_nop 0
    s_cmp_ge_u32 s76, s55
    s_cbranch_scc1 L_lwd100
    s_sleep 1
    s_sub_u32 s56, s56, 1
    s_cbranch_scc0 L_lw100
L_lwd100:
    ds_write_b128 v27, v[32:35] offset:0
    ds_write_b128 v27, v[36:39] offset:4096
    ds_write_b128 v27, v[40:43] offset:8192
    s_mov_b64 exec, 1
    ds_add_u32 v10, v11 offset:0
    s_mov_b64 exec, -1
    ds_write_b128 v27, v[44:47] offset:12288
    ds_write_b128 v27, v[48:51] offset:16384
    ds_write_b128 v27, v[52:55] offset:20480
    s_mov_b64 exec, 1
    ds_add_u32 v10, v11 offset:4
    s_mov_b64 exec, -1
    ds_write_b128 v27, v[56:59] offset:24576
    ds_write_b128 v27, v[60:63] offset:28672
    ds_write_b128 v27, v[64:67] offset:32768
    s_mov_b64 exec, 1
    ds_add_u32 v10, v11 offset:8
    s_mov_b64 exec, -1
    ds_write_b128 v27, v[68:71] offset:36864
    ds_write_b128 v27, v[72:75] offset:40960
    ds_write_b128 v27, v[76:79] offset:45056
    s_mov_b64 exec, 1
    ds_add_u32 v10, v11 offset:12
    s_mov_b64 exec, -1
    ds_write_b128 v27, v[80:83] offset:49152
    ds_write_b128 v27, v[84:87] offset:53248
    ds_write_b128 v27, v[88:91] offset:57344
    s_mov_b64 exec, 1
    ds_add_u32 v10, v11 offset:16
    s_mov_b64 exec, -1
    s_mov_b32 s56, 4000000
L_lw101:
    ds_read_b32 v8, v10 offset:68
    s_waitcnt lgkmcnt(0)
    v_readfirstlane_b32 s76, v8
    s_nop 0
    s_cmp_ge_u32 s76, s55
    s_cbranch_scc1 L_lwd101
    s_sleep 1
    s_sub_u32 s56, s56, 1
    s_cbranch_scc0 L_lw101
L_lwd101:
    ds_write_b128 v9, v[92:95] offset:0
    ds_write_b128 v9, v[96:99] offset:4096
    ds_write_b128 v9, v[100:103] offset:8192
    s_mov_b64 exec, 1
    ds_add_u32 v10, v11 offset:20
    s_mov_b64 exec, -1
    ds_write_b128 v9, v[104:107] offset:12288
    ds_write_b128 v9, v[108:111] offset:16384
    ds_write_b128 v9, v[112:115] offset:20480
    s_mov_b64 exec, 1
    ds_add_u32 v10, v11 offset:24
    s_mov_b64 exec, -1
    ds_write_b128 v9, v[116:119] offset:24576
    ds_write_b128 v9, v[120:123] offset:28672
    ds_write_b128 v9, v[124:127] offset:32768
    s_mov_b64 exec, 1
    ds_add_u32 v10, v11 offset:28
    s_mov_b64 exec, -1
    s_add_u32 s53, s53, 1
    s_add_u32 s55, s55, 4
    s_add_u32 s44, s44, 8192
    s_mov_b32 s52, 1
    s_add_u32 s46, s46, 4
    s_branch L_H_loop
L_H_last:
L_end:
    s_endpgm
L_codeend:
.section .rodata,"a"
.p2align 6
.amdhsa_kernel interleave_layers__linear_kernel_hedgehog__sliding_local_dilated__prompt_kernel
  .amdhsa_next_free_vgpr 256
  .amdhsa_next_free_sgpr 102
  .amdhsa_accum_offset 256
  .amdhsa_group_segment_fixed_size 0
  .amdhsa_kernarg_size 80
  .amdhsa_user_sgpr_count 2
  .amdhsa_user_sgpr_kernarg_segment_ptr 1
  .amdhsa_system_sgpr_workgroup_id_x 1
.end_amdhsa_kernel
```
